```python
import torch

def _softmax(x, axis=-1):
    return torch.softmax(x, dim=axis)
def _gelu(x):
    return torch.nn.functional.gelu(x, approximate="tanh")
def _silu(x):
    return torch.nn.functional.silu(x)
def _sigmoid(x):
    return torch.sigmoid(x)
def _layernorm(x, axis=-1, eps=1e-5):
    m = x.mean(dim=axis, keepdim=True)
    v = x.var(dim=axis, keepdim=True, unbiased=False)
    return (x - m) / torch.sqrt(v + eps)
def _scatter_add(tgt, idx, src, axis=0):
    return tgt.clone().index_add_(axis, idx, src)
def _segment_sum(src, seg, n):
    out = torch.zeros((n,) + src.shape[1:], dtype=src.dtype)
    return out.index_add_(0, seg, src)
def _pad(x, pw):
    flat = tuple(v for pair in reversed(pw) for v in pair)
    return torch.nn.functional.pad(x, flat)

kernel_name = 'recurrent_scan__gqa_block_cached__mixer_token_mlp__decode'

def setup_inputs():

    _w = (lambda a: (lambda t: t.to(torch.bfloat16) if t.is_floating_point() else t)(torch.as_tensor(a)))
    def _A_setup():
        B, Sq, D = 2, 1, 576
        Hq, Hkv, Sk, Dh = 32, 16, 8192, 128
        assert Hq % Hkv == 0, (Hq, Hkv)
        return {
            "x": _w((lambda *s: torch.randn(*s, dtype=torch.bfloat16) * 0.1)(B, Sq, D)),
            "k_cache": _w((lambda *s: torch.randn(*s, dtype=torch.bfloat16) * 0.8)(B, Hkv, Sk, Dh)),
            "v_cache": _w((lambda *s: torch.randn(*s, dtype=torch.bfloat16) * 3.2)(B, Hkv, Sk, Dh)),
            "wq": _w((lambda *s: torch.randn(*s, dtype=torch.bfloat16) * 0.8)(D, Hq * Dh) * (D ** -0.5)),
            "wo": _w((lambda *s: torch.randn(*s, dtype=torch.bfloat16) * 3.2)(Hq * Dh, D) * ((Hq * Dh) ** -0.5)),
        }
    _A_in = _A_setup()

    def _B_setup():
        B, S, D, F = 2, 1, 576, 4608
        return {
            "x": _w((lambda *s: torch.randn(*s, dtype=torch.bfloat16) * 0.1)(B, S, D)),
            "w1": _w((lambda *s: torch.randn(*s, dtype=torch.bfloat16) * 3.2)(S, F) * (S ** -0.5)),
            "b1": _w((lambda *s: torch.randn(*s, dtype=torch.bfloat16) * 3.2)(F) * 0.02),
            "w2": _w((lambda *s: torch.randn(*s, dtype=torch.bfloat16) * 3.2)(F, S) * (F ** -0.5)),
            "b2": _w((lambda *s: torch.randn(*s, dtype=torch.bfloat16) * 3.2)(S) * 0.02),
        }
    _B_in = _B_setup()

    return {
        "A_x": _A_in["x"],
        "A_k_cache": _A_in["k_cache"],
        "A_v_cache": _A_in["v_cache"],
        "A_wq": _A_in["wq"],
        "A_wo": _A_in["wo"],
        "B_x": _B_in["x"],
        "B_w1": _B_in["w1"],
        "B_b1": _B_in["b1"],
        "B_w2": _B_in["w2"],
        "B_b2": _B_in["b2"],
    }

def reference(A_x, A_k_cache, A_v_cache, A_wq, A_wo, B_x, B_w1, B_b1, B_w2, B_b2):
    def _A_ref(x, k_cache, v_cache, wq, wo):
        B, Sq, D = x.shape
        Hq, Dh = 32, 128
        Hkv = k_cache.shape[1]
        rep = Hq // Hkv
        q = (lambda x, *d: x.permute(*d))((x @ wq).reshape(B, Sq, Hq, Dh), 0, 2, 1, 3)
        k = (lambda x, n, axis: torch.repeat_interleave(x, n, dim=axis))(k_cache, rep, axis=1)
        v = (lambda x, n, axis: torch.repeat_interleave(x, n, dim=axis))(v_cache, rep, axis=1)
        scores = torch.einsum("bhqd,bhkd->bhqk", q, k) * (Dh ** -0.5)
        p = _softmax(scores, axis=-1)
        o = torch.einsum("bhqk,bhkd->bhqd", p, v)
        return (lambda x, *d: x.permute(*d))(o, 0, 2, 1, 3).reshape(B, Sq, Hq * Dh) @ wo

    def _B_ref(x, w1, b1, w2, b2):
        B, S, D = x.shape
        h = _layernorm(x, axis=-1)
        u = torch.einsum("bsd,sf->bdf", h, w1) + b1
        u = _gelu(u)
        y = torch.einsum("bdf,fs->bds", u, w2) + b2
        return (lambda x, *d: x.permute(*d))(y, 0, 2, 1)

    x = A_x
    xn = _layernorm(x, axis=-1)
    s = _A_ref(xn, A_k_cache, A_v_cache, A_wq, A_wo)
    g = _silu(_B_ref(xn, B_w1, B_b1, B_w2, B_b2))
    return x + s * g
```

```asm
; @launch grid=(256,1,1) block=(512,1,1) lds=55552
.amdgcn_target "amdgcn-amd-amdhsa--gfx950"
.text
.globl recurrent_scan__gqa_block_cached__mixer_token_mlp__decode_kernel
.p2align 8
.type recurrent_scan__gqa_block_cached__mixer_token_mlp__decode_kernel,@function
recurrent_scan__gqa_block_cached__mixer_token_mlp__decode_kernel:
    s_load_dwordx16 s[4:19], s[0:1], 0
    s_load_dwordx8 s[20:27], s[0:1], 64
    s_load_dwordx2 s[28:29], s[0:1], 96
    v_lshrrev_b32 v3, 6, v0
    v_and_b32 v1, 63, v0
    s_cmp_ge_u32 s2, 256
    s_cbranch_scc1 L_END
    v_readfirstlane_b32 s40, v3
    v_lshlrev_b32 v2, 4, v1
    s_and_b32 s41, s2, 7
    s_lshr_b32 s49, s2, 7
    s_lshl_b32 s49, s49, 3
    s_or_b32 s41, s41, s49
    s_bfe_u32 s44, s2, 0x40003
    s_and_b32 s43, s44, 7
    s_lshr_b32 s42, s44, 3
    s_and_b32 s49, s40, 3
    s_lshl_b32 s48, s49, 10
    s_add_u32 s49, s40, 7
    s_bfe_u32 s45, s49, 0x10002
    s_lshl_b32 s49, s45, 17
    s_or_b32 s48, s48, s49
    s_lshl_b32 s49, s43, 18
    s_or_b32 s48, s48, s49
    s_bfe_u32 s49, s2, 0x30003
    s_lshl_b32 s49, s49, 12
    s_or_b32 s48, s48, s49
    s_lshl_b32 s49, s42, 4
    s_or_b32 s49, s49, s41
    s_lshl_b32 s49, s49, 21
    s_and_b32 s50, s44, 1
    s_lshr_b32 s69, s44, 1
    s_lshl_b32 s68, s41, 1
    s_or_b32 s68, s68, s50
    s_mov_b32 s34, 2097152
    s_mov_b32 s35, 0x20000
    s_mov_b32 s38, 2097152
    s_mov_b32 s39, 0x20000
    s_waitcnt lgkmcnt(0)
    s_add_u32 s32, s6, s49
    s_addc_u32 s33, s7, 0
    s_add_u32 s36, s8, s49
    s_addc_u32 s37, s9, 0
    s_cmp_eq_u32 s45, 1
    s_cbranch_scc1 L_SERVICE
    s_xor_b32 s49, s48, 0
    buffer_load_dwordx4 v[40:43], v2, s[32:35], s49 offen nt
    s_xor_b32 s49, s48, 4096
    buffer_load_dwordx4 v[44:47], v2, s[32:35], s49 offen nt
    s_xor_b32 s49, s48, 8192
    buffer_load_dwordx4 v[48:51], v2, s[32:35], s49 offen nt
    s_xor_b32 s49, s48, 12288
    buffer_load_dwordx4 v[52:55], v2, s[32:35], s49 offen nt
    s_xor_b32 s49, s48, 16384
    buffer_load_dwordx4 v[56:59], v2, s[32:35], s49 offen nt
    s_xor_b32 s49, s48, 20480
    buffer_load_dwordx4 v[60:63], v2, s[32:35], s49 offen nt
    s_xor_b32 s49, s48, 24576
    buffer_load_dwordx4 v[64:67], v2, s[32:35], s49 offen nt
    s_xor_b32 s49, s48, 28672
    buffer_load_dwordx4 v[68:71], v2, s[32:35], s49 offen nt
    s_mov_b32 s47, s68
    s_mov_b32 s46, s69
    s_lshl_b32 s55, s41, 4
    s_add_u32 s55, s55, s44
    s_mul_i32 s55, s55, 640
    s_add_u32 s55, s55, 262144
    s_lshl_b32 s70, s46, 5
    s_add_u32 s70, s70, s47
    s_mul_i32 s70, s70, 768
    s_lshr_b32 s31, s2, 3
    s_and_b32 s3, s2, 7
    s_lshl_b32 s30, s3, 5
    s_add_u32 s30, s30, s31
    s_mul_i32 s30, s30, 768
    v_and_b32 v19, 1, v1
    v_lshlrev_b32 v19, 4, v19
    v_mov_b32 v18, 0xffff
    v_lshlrev_b32 v19, v19, v18
    v_bfe_u32 v8, v1, 1, 2
    v_cmp_eq_u32 vcc, 0, v8
    s_nop 1
    v_cndmask_b32 v16, 0, v19, vcc
    v_cmp_eq_u32 vcc, 1, v8
    s_nop 1
    v_cndmask_b32 v17, 0, v19, vcc
    v_cmp_eq_u32 vcc, 2, v8
    s_nop 1
    v_cndmask_b32 v18, 0, v19, vcc
    v_cmp_eq_u32 vcc, 3, v8
    s_nop 1
    v_cndmask_b32 v19, 0, v19, vcc
    s_mov_b32 s54, 0x3fb8aa3b
    v_mov_b32 v38, 0
    s_cmp_lg_u32 s40, 1
    s_cbranch_scc1 L_NOINIT
    v_lshlrev_b32 v3, 2, v1
    s_mov_b64 exec, 0xffff
    ds_write_b32 v3, v38 offset:0
    s_mov_b64 exec, -1
    s_waitcnt lgkmcnt(0)
L_NOINIT:
    s_barrier
    s_xor_b32 s49, s48, 32768
    buffer_load_dwordx4 v[72:75], v2, s[32:35], s49 offen nt
    s_xor_b32 s49, s48, 36864
    buffer_load_dwordx4 v[76:79], v2, s[32:35], s49 offen nt
    s_xor_b32 s49, s48, 40960
    buffer_load_dwordx4 v[80:83], v2, s[32:35], s49 offen nt
    s_xor_b32 s49, s48, 45056
    buffer_load_dwordx4 v[84:87], v2, s[32:35], s49 offen nt
    s_xor_b32 s49, s48, 49152
    buffer_load_dwordx4 v[88:91], v2, s[32:35], s49 offen nt
    s_xor_b32 s49, s48, 53248
    buffer_load_dwordx4 v[92:95], v2, s[32:35], s49 offen nt
    s_xor_b32 s49, s48, 57344
    buffer_load_dwordx4 v[96:99], v2, s[32:35], s49 offen nt
    s_xor_b32 s49, s48, 61440
    buffer_load_dwordx4 v[100:103], v2, s[32:35], s49 offen nt
    s_xor_b32 s49, s48, 65536
    buffer_load_dwordx4 v[104:107], v2, s[32:35], s49 offen nt
    s_xor_b32 s49, s48, 69632
    buffer_load_dwordx4 v[108:111], v2, s[32:35], s49 offen nt
    s_xor_b32 s49, s48, 73728
    buffer_load_dwordx4 v[112:115], v2, s[32:35], s49 offen nt
    s_xor_b32 s49, s48, 77824
    buffer_load_dwordx4 v[116:119], v2, s[32:35], s49 offen nt
    s_cmp_eq_u32 s40, 4
    s_cbranch_scc1 L_NOWO
    s_mov_b32 s14, 4718592
    s_mov_b32 s15, 0x20000
    s_sub_u32 s51, s40, 1
    s_mul_i32 s51, s51, 384
    v_add_u32 v38, s51, v1
    s_mul_i32 s51, s47, 147456
    s_mul_i32 s50, s46, 144
    s_add_u32 s51, s51, s50
    s_mov_b32 s50, 7282
    v_add_u32 v28, 0, v38
    v_mul_u32_u24 v29, s50, v28
    v_lshrrev_b32 v29, 16, v29
    v_mul_u32_u24 v29, 1008, v29
    v_lshl_add_u32 v30, v28, 4, v29
    buffer_load_dwordx4 a[60:63], v30, s[12:15], s51 offen
    v_add_u32 v28, 64, v38
    v_mul_u32_u24 v29, s50, v28
    v_lshrrev_b32 v29, 16, v29
    v_mul_u32_u24 v29, 1008, v29
    v_lshl_add_u32 v30, v28, 4, v29
    buffer_load_dwordx4 a[64:67], v30, s[12:15], s51 offen
    v_add_u32 v28, 128, v38
    v_mul_u32_u24 v29, s50, v28
    v_lshrrev_b32 v29, 16, v29
    v_mul_u32_u24 v29, 1008, v29
    v_lshl_add_u32 v30, v28, 4, v29
    buffer_load_dwordx4 a[68:71], v30, s[12:15], s51 offen
    v_add_u32 v28, 192, v38
    v_mul_u32_u24 v29, s50, v28
    v_lshrrev_b32 v29, 16, v29
    v_mul_u32_u24 v29, 1008, v29
    v_lshl_add_u32 v30, v28, 4, v29
    buffer_load_dwordx4 a[72:75], v30, s[12:15], s51 offen
    v_add_u32 v28, 256, v38
    v_mul_u32_u24 v29, s50, v28
    v_lshrrev_b32 v29, 16, v29
    v_mul_u32_u24 v29, 1008, v29
    v_lshl_add_u32 v30, v28, 4, v29
    buffer_load_dwordx4 a[76:79], v30, s[12:15], s51 offen
    v_add_u32 v28, 320, v38
    v_mul_u32_u24 v29, s50, v28
    v_lshrrev_b32 v29, 16, v29
    v_mul_u32_u24 v29, 1008, v29
    v_lshl_add_u32 v30, v28, 4, v29
    buffer_load_dwordx4 a[80:83], v30, s[12:15], s51 offen
    v_lshlrev_b32 v38, 4, v38
    s_nop 1
L_NOWO:
L_STREAM2:
    s_xor_b32 s49, s48, 81920
    buffer_load_dwordx4 v[120:123], v2, s[32:35], s49 offen nt
    s_xor_b32 s49, s48, 86016
    buffer_load_dwordx4 v[124:127], v2, s[32:35], s49 offen nt
    s_xor_b32 s49, s48, 90112
    buffer_load_dwordx4 v[128:131], v2, s[32:35], s49 offen nt
    s_xor_b32 s49, s48, 94208
    buffer_load_dwordx4 v[132:135], v2, s[32:35], s49 offen nt
    s_xor_b32 s49, s48, 98304
    buffer_load_dwordx4 v[136:139], v2, s[32:35], s49 offen nt
    s_xor_b32 s49, s48, 102400
    buffer_load_dwordx4 v[140:143], v2, s[32:35], s49 offen nt
    s_xor_b32 s49, s48, 106496
    buffer_load_dwordx4 v[144:147], v2, s[32:35], s49 offen nt
    s_xor_b32 s49, s48, 110592
    buffer_load_dwordx4 v[148:151], v2, s[32:35], s49 offen nt
    s_xor_b32 s49, s48, 114688
    buffer_load_dwordx4 v[152:155], v2, s[32:35], s49 offen nt
    s_xor_b32 s49, s48, 118784
    buffer_load_dwordx4 v[156:159], v2, s[32:35], s49 offen nt
    s_xor_b32 s49, s48, 122880
    buffer_load_dwordx4 v[160:163], v2, s[32:35], s49 offen nt
    s_xor_b32 s49, s48, 126976
    buffer_load_dwordx4 v[164:167], v2, s[32:35], s49 offen nt
    s_xor_b32 s49, s48, 0
    buffer_load_dwordx4 a[0:3], v2, s[36:39], s49 offen nt
    s_xor_b32 s49, s48, 4096
    buffer_load_dwordx4 a[4:7], v2, s[36:39], s49 offen nt
    s_xor_b32 s49, s48, 8192
    buffer_load_dwordx4 a[8:11], v2, s[36:39], s49 offen nt
    s_xor_b32 s49, s48, 12288
    buffer_load_dwordx4 a[12:15], v2, s[36:39], s49 offen nt
    s_cmp_eq_u32 s45, 1
    s_cbranch_scc1 L_LATE0
    s_xor_b32 s49, s48, 16384
    buffer_load_dwordx4 a[16:19], v2, s[36:39], s49 offen nt
    s_xor_b32 s49, s48, 20480
    buffer_load_dwordx4 a[20:23], v2, s[36:39], s49 offen nt
    s_xor_b32 s49, s48, 24576
    buffer_load_dwordx4 a[24:27], v2, s[36:39], s49 offen nt
    s_xor_b32 s49, s48, 28672
    buffer_load_dwordx4 a[28:31], v2, s[36:39], s49 offen nt
    s_xor_b32 s49, s48, 32768
    buffer_load_dwordx4 a[32:35], v2, s[36:39], s49 offen nt
    s_xor_b32 s49, s48, 36864
    buffer_load_dwordx4 a[36:39], v2, s[36:39], s49 offen nt
    s_xor_b32 s49, s48, 40960
    buffer_load_dwordx4 a[40:43], v2, s[36:39], s49 offen nt
    s_xor_b32 s49, s48, 45056
    buffer_load_dwordx4 a[44:47], v2, s[36:39], s49 offen nt
    s_xor_b32 s49, s48, 49152
    buffer_load_dwordx4 a[48:51], v2, s[36:39], s49 offen nt
    s_xor_b32 s49, s48, 53248
    buffer_load_dwordx4 a[52:55], v2, s[36:39], s49 offen nt
    s_cmp_eq_u32 s40, 4
    s_cbranch_scc1 L_NOWO2
    s_waitcnt vmcnt(26)
    ds_write_b128 v38, a[60:63] offset:18432
    ds_write_b128 v38, a[64:67] offset:19456
    ds_write_b128 v38, a[68:71] offset:20480
    ds_write_b128 v38, a[72:75] offset:21504
    ds_write_b128 v38, a[76:79] offset:22528
    ds_write_b128 v38, a[80:83] offset:23552
    v_mov_b32 v34, 1
    v_mov_b32 v35, 16
    s_mov_b64 exec, 1
    ds_add_u32 v35, v34
    s_mov_b64 exec, -1
    s_waitcnt lgkmcnt(0)
L_NOWO2:
    s_xor_b32 s49, s48, 57344
    buffer_load_dwordx4 a[56:59], v2, s[36:39], s49 offen nt
    s_xor_b32 s49, s48, 61440
    buffer_load_dwordx4 a[60:63], v2, s[36:39], s49 offen nt
    s_xor_b32 s49, s48, 65536
    buffer_load_dwordx4 a[64:67], v2, s[36:39], s49 offen nt
    s_xor_b32 s49, s48, 69632
    buffer_load_dwordx4 a[68:71], v2, s[36:39], s49 offen nt
    s_xor_b32 s49, s48, 73728
    buffer_load_dwordx4 a[72:75], v2, s[36:39], s49 offen nt
    s_xor_b32 s49, s48, 77824
    buffer_load_dwordx4 a[76:79], v2, s[36:39], s49 offen nt
    s_xor_b32 s49, s48, 81920
    buffer_load_dwordx4 a[80:83], v2, s[36:39], s49 offen nt
    s_xor_b32 s49, s48, 86016
    buffer_load_dwordx4 a[84:87], v2, s[36:39], s49 offen nt
L_LATE0:
    v_mov_b32 v31, 0
    s_mov_b32 s52, 131072
    s_nop 0
L_QW:
    ds_read_b32 v28, v31
    s_waitcnt lgkmcnt(0)
    v_readfirstlane_b32 s50, v28
    s_nop 0
    s_cmp_lg_u32 s50, 0
    s_cbranch_scc1 L_QW_OK
    s_sleep 2
    s_sub_u32 s52, s52, 1
    s_cmp_lg_u32 s52, 0
    s_cbranch_scc1 L_QW
L_QW_OK:
    s_mov_b32 s74, s50
    v_bfe_u32 v28, v1, 3, 1
    v_lshlrev_b32 v28, 8, v28
    v_and_b32 v29, 15, v1
    v_lshl_add_u32 v28, v29, 4, v28
    v_xor_b32 v29, 128, v28
    ds_read_b128 v[8:11], v28 offset:256
    ds_read_b128 v[12:15], v29 offset:256
    v_lshlrev_b32 v30, 2, v1
    ds_read_b32 v0, v30 offset:768
    s_waitcnt lgkmcnt(0)
    s_cmp_eq_u32 s45, 1
    s_cbranch_scc1 L_NOEP
    s_setprio 1
L_NOEP:
    s_waitcnt vmcnt(32)
    v_dot2_f32_bf16 v28, v40, v8, 0
    v_dot2_f32_bf16 v29, v44, v8, 0
    v_dot2_f32_bf16 v30, v48, v8, 0
    v_dot2_f32_bf16 v31, v52, v8, 0
    v_dot2c_f32_bf16 v28, v41, v9
    v_dot2c_f32_bf16 v29, v45, v9
    v_dot2c_f32_bf16 v30, v49, v9
    v_dot2c_f32_bf16 v31, v53, v9
    v_dot2c_f32_bf16 v28, v42, v10
    v_dot2c_f32_bf16 v29, v46, v10
    v_dot2c_f32_bf16 v30, v50, v10
    v_dot2c_f32_bf16 v31, v54, v10
    v_dot2c_f32_bf16 v28, v43, v11
    v_dot2c_f32_bf16 v29, v47, v11
    v_dot2c_f32_bf16 v30, v51, v11
    v_dot2c_f32_bf16 v31, v55, v11
    v_dot2c_f32_bf16_dpp v28, v40, v12 row_ror:8 row_mask:0xf bank_mask:0xf
    v_dot2c_f32_bf16_dpp v29, v44, v12 row_ror:8 row_mask:0xf bank_mask:0xf
    v_dot2c_f32_bf16_dpp v30, v48, v12 row_ror:8 row_mask:0xf bank_mask:0xf
    v_dot2c_f32_bf16_dpp v31, v52, v12 row_ror:8 row_mask:0xf bank_mask:0xf
    v_dot2c_f32_bf16_dpp v28, v41, v13 row_ror:8 row_mask:0xf bank_mask:0xf
    v_dot2c_f32_bf16_dpp v29, v45, v13 row_ror:8 row_mask:0xf bank_mask:0xf
    v_dot2c_f32_bf16_dpp v30, v49, v13 row_ror:8 row_mask:0xf bank_mask:0xf
    v_dot2c_f32_bf16_dpp v31, v53, v13 row_ror:8 row_mask:0xf bank_mask:0xf
    v_dot2c_f32_bf16_dpp v28, v42, v14 row_ror:8 row_mask:0xf bank_mask:0xf
    v_dot2c_f32_bf16_dpp v29, v46, v14 row_ror:8 row_mask:0xf bank_mask:0xf
    v_dot2c_f32_bf16_dpp v30, v50, v14 row_ror:8 row_mask:0xf bank_mask:0xf
    v_dot2c_f32_bf16_dpp v31, v54, v14 row_ror:8 row_mask:0xf bank_mask:0xf
    v_dot2c_f32_bf16_dpp v28, v43, v15 row_ror:8 row_mask:0xf bank_mask:0xf
    v_dot2c_f32_bf16_dpp v29, v47, v15 row_ror:8 row_mask:0xf bank_mask:0xf
    v_dot2c_f32_bf16_dpp v30, v51, v15 row_ror:8 row_mask:0xf bank_mask:0xf
    v_dot2c_f32_bf16_dpp v31, v55, v15 row_ror:8 row_mask:0xf bank_mask:0xf
    s_cmp_eq_u32 s45, 0
    s_nop 0
    s_cbranch_scc1 L_SK1
    s_xor_b32 s49, s48, 16384
    buffer_load_dwordx4 a[16:19], v2, s[36:39], s49 offen nt
    s_xor_b32 s49, s48, 20480
    buffer_load_dwordx4 a[20:23], v2, s[36:39], s49 offen nt
    s_branch L_SJ1
L_SK1:
    s_xor_b32 s49, s48, 90112
    buffer_load_dwordx4 v[40:43], v2, s[36:39], s49 offen nt
    s_xor_b32 s49, s48, 94208
    buffer_load_dwordx4 v[44:47], v2, s[36:39], s49 offen nt
    s_xor_b32 s49, s48, 98304
    buffer_load_dwordx4 v[48:51], v2, s[36:39], s49 offen nt
L_SJ1:
    v_add_f32_dpp v28, v28, v28 quad_perm:[1,0,3,2] row_mask:0xf bank_mask:0xf
    v_add_f32_dpp v29, v29, v29 quad_perm:[1,0,3,2] row_mask:0xf bank_mask:0xf
    v_add_f32_dpp v30, v30, v30 quad_perm:[1,0,3,2] row_mask:0xf bank_mask:0xf
    v_add_f32_dpp v31, v31, v31 quad_perm:[1,0,3,2] row_mask:0xf bank_mask:0xf
    v_add_f32_dpp v28, v28, v28 quad_perm:[2,3,0,1] row_mask:0xf bank_mask:0xf
    v_add_f32_dpp v29, v29, v29 quad_perm:[2,3,0,1] row_mask:0xf bank_mask:0xf
    v_add_f32_dpp v30, v30, v30 quad_perm:[2,3,0,1] row_mask:0xf bank_mask:0xf
    v_add_f32_dpp v31, v31, v31 quad_perm:[2,3,0,1] row_mask:0xf bank_mask:0xf
    v_add_f32_dpp v52, v28, v28 row_half_mirror row_mask:0xf bank_mask:0xf
    v_add_f32_dpp v53, v29, v29 row_half_mirror row_mask:0xf bank_mask:0xf
    v_add_f32_dpp v54, v30, v30 row_half_mirror row_mask:0xf bank_mask:0xf
    v_add_f32_dpp v55, v31, v31 row_half_mirror row_mask:0xf bank_mask:0xf
    v_cvt_pk_bf16_f32 v32, v52, v53
    v_cvt_pk_bf16_f32 v33, v54, v55
    v_lshlrev_b32 v52, 16, v32
    v_and_b32 v53, 0xffff0000, v32
    v_lshlrev_b32 v54, 16, v33
    v_and_b32 v55, 0xffff0000, v33
    v_mul_f32 v52, 0x3db504f3, v52
    v_mul_f32 v53, 0x3db504f3, v53
    v_mul_f32 v54, 0x3db504f3, v54
    v_mul_f32 v55, 0x3db504f3, v55
    v_cvt_pk_bf16_f32 v32, v52, v53
    v_cvt_pk_bf16_f32 v33, v54, v55
    v_lshlrev_b32 v52, 16, v32
    v_and_b32 v53, 0xffff0000, v32
    v_lshlrev_b32 v54, 16, v33
    v_and_b32 v55, 0xffff0000, v33
    v_max3_f32 v36, v52, v53, v54
    v_max_f32 v36, v36, v55
    s_waitcnt vmcnt(30)
    v_dot2_f32_bf16 v28, v56, v8, 0
    v_dot2_f32_bf16 v29, v60, v8, 0
    v_dot2_f32_bf16 v30, v64, v8, 0
    v_dot2_f32_bf16 v31, v68, v8, 0
    v_dot2c_f32_bf16 v28, v57, v9
    v_dot2c_f32_bf16 v29, v61, v9
    v_dot2c_f32_bf16 v30, v65, v9
    v_dot2c_f32_bf16 v31, v69, v9
    v_dot2c_f32_bf16 v28, v58, v10
    v_dot2c_f32_bf16 v29, v62, v10
    v_dot2c_f32_bf16 v30, v66, v10
    v_dot2c_f32_bf16 v31, v70, v10
    v_dot2c_f32_bf16 v28, v59, v11
    v_dot2c_f32_bf16 v29, v63, v11
    v_dot2c_f32_bf16 v30, v67, v11
    v_dot2c_f32_bf16 v31, v71, v11
    v_dot2c_f32_bf16_dpp v28, v56, v12 row_ror:8 row_mask:0xf bank_mask:0xf
    v_dot2c_f32_bf16_dpp v29, v60, v12 row_ror:8 row_mask:0xf bank_mask:0xf
    v_dot2c_f32_bf16_dpp v30, v64, v12 row_ror:8 row_mask:0xf bank_mask:0xf
    v_dot2c_f32_bf16_dpp v31, v68, v12 row_ror:8 row_mask:0xf bank_mask:0xf
    v_dot2c_f32_bf16_dpp v28, v57, v13 row_ror:8 row_mask:0xf bank_mask:0xf
    v_dot2c_f32_bf16_dpp v29, v61, v13 row_ror:8 row_mask:0xf bank_mask:0xf
    v_dot2c_f32_bf16_dpp v30, v65, v13 row_ror:8 row_mask:0xf bank_mask:0xf
    v_dot2c_f32_bf16_dpp v31, v69, v13 row_ror:8 row_mask:0xf bank_mask:0xf
    v_dot2c_f32_bf16_dpp v28, v58, v14 row_ror:8 row_mask:0xf bank_mask:0xf
    v_dot2c_f32_bf16_dpp v29, v62, v14 row_ror:8 row_mask:0xf bank_mask:0xf
    v_dot2c_f32_bf16_dpp v30, v66, v14 row_ror:8 row_mask:0xf bank_mask:0xf
    v_dot2c_f32_bf16_dpp v31, v70, v14 row_ror:8 row_mask:0xf bank_mask:0xf
    v_dot2c_f32_bf16_dpp v28, v59, v15 row_ror:8 row_mask:0xf bank_mask:0xf
    v_dot2c_f32_bf16_dpp v29, v63, v15 row_ror:8 row_mask:0xf bank_mask:0xf
    v_dot2c_f32_bf16_dpp v30, v67, v15 row_ror:8 row_mask:0xf bank_mask:0xf
    v_dot2c_f32_bf16_dpp v31, v71, v15 row_ror:8 row_mask:0xf bank_mask:0xf
    s_cmp_eq_u32 s45, 0
    s_nop 0
    s_cbranch_scc1 L_SK2
    s_xor_b32 s49, s48, 24576
    buffer_load_dwordx4 a[24:27], v2, s[36:39], s49 offen nt
    s_xor_b32 s49, s48, 28672
    buffer_load_dwordx4 a[28:31], v2, s[36:39], s49 offen nt
    s_branch L_SJ2
L_SK2:
    s_xor_b32 s49, s48, 102400
    buffer_load_dwordx4 v[56:59], v2, s[36:39], s49 offen nt
    s_xor_b32 s49, s48, 106496
    buffer_load_dwordx4 v[60:63], v2, s[36:39], s49 offen nt
    s_xor_b32 s49, s48, 110592
    buffer_load_dwordx4 v[64:67], v2, s[36:39], s49 offen nt
L_SJ2:
    v_add_f32_dpp v28, v28, v28 quad_perm:[1,0,3,2] row_mask:0xf bank_mask:0xf
    v_add_f32_dpp v29, v29, v29 quad_perm:[1,0,3,2] row_mask:0xf bank_mask:0xf
    v_add_f32_dpp v30, v30, v30 quad_perm:[1,0,3,2] row_mask:0xf bank_mask:0xf
    v_add_f32_dpp v31, v31, v31 quad_perm:[1,0,3,2] row_mask:0xf bank_mask:0xf
    v_add_f32_dpp v28, v28, v28 quad_perm:[2,3,0,1] row_mask:0xf bank_mask:0xf
    v_add_f32_dpp v29, v29, v29 quad_perm:[2,3,0,1] row_mask:0xf bank_mask:0xf
    v_add_f32_dpp v30, v30, v30 quad_perm:[2,3,0,1] row_mask:0xf bank_mask:0xf
    v_add_f32_dpp v31, v31, v31 quad_perm:[2,3,0,1] row_mask:0xf bank_mask:0xf
    v_add_f32_dpp v68, v28, v28 row_half_mirror row_mask:0xf bank_mask:0xf
    v_add_f32_dpp v69, v29, v29 row_half_mirror row_mask:0xf bank_mask:0xf
    v_add_f32_dpp v70, v30, v30 row_half_mirror row_mask:0xf bank_mask:0xf
    v_add_f32_dpp v71, v31, v31 row_half_mirror row_mask:0xf bank_mask:0xf
    v_cvt_pk_bf16_f32 v32, v68, v69
    v_cvt_pk_bf16_f32 v33, v70, v71
    v_lshlrev_b32 v68, 16, v32
    v_and_b32 v69, 0xffff0000, v32
    v_lshlrev_b32 v70, 16, v33
    v_and_b32 v71, 0xffff0000, v33
    v_mul_f32 v68, 0x3db504f3, v68
    v_mul_f32 v69, 0x3db504f3, v69
    v_mul_f32 v70, 0x3db504f3, v70
    v_mul_f32 v71, 0x3db504f3, v71
    v_cvt_pk_bf16_f32 v32, v68, v69
    v_cvt_pk_bf16_f32 v33, v70, v71
    v_lshlrev_b32 v68, 16, v32
    v_and_b32 v69, 0xffff0000, v32
    v_lshlrev_b32 v70, 16, v33
    v_and_b32 v71, 0xffff0000, v33
    v_max3_f32 v36, v36, v68, v69
    v_max3_f32 v36, v36, v70, v71
    s_waitcnt vmcnt(28)
    v_dot2_f32_bf16 v28, v72, v8, 0
    v_dot2_f32_bf16 v29, v76, v8, 0
    v_dot2_f32_bf16 v30, v80, v8, 0
    v_dot2_f32_bf16 v31, v84, v8, 0
    v_dot2c_f32_bf16 v28, v73, v9
    v_dot2c_f32_bf16 v29, v77, v9
    v_dot2c_f32_bf16 v30, v81, v9
    v_dot2c_f32_bf16 v31, v85, v9
    v_dot2c_f32_bf16 v28, v74, v10
    v_dot2c_f32_bf16 v29, v78, v10
    v_dot2c_f32_bf16 v30, v82, v10
    v_dot2c_f32_bf16 v31, v86, v10
    v_dot2c_f32_bf16 v28, v75, v11
    v_dot2c_f32_bf16 v29, v79, v11
    v_dot2c_f32_bf16 v30, v83, v11
    v_dot2c_f32_bf16 v31, v87, v11
    v_dot2c_f32_bf16_dpp v28, v72, v12 row_ror:8 row_mask:0xf bank_mask:0xf
    v_dot2c_f32_bf16_dpp v29, v76, v12 row_ror:8 row_mask:0xf bank_mask:0xf
    v_dot2c_f32_bf16_dpp v30, v80, v12 row_ror:8 row_mask:0xf bank_mask:0xf
    v_dot2c_f32_bf16_dpp v31, v84, v12 row_ror:8 row_mask:0xf bank_mask:0xf
    v_dot2c_f32_bf16_dpp v28, v73, v13 row_ror:8 row_mask:0xf bank_mask:0xf
    v_dot2c_f32_bf16_dpp v29, v77, v13 row_ror:8 row_mask:0xf bank_mask:0xf
    v_dot2c_f32_bf16_dpp v30, v81, v13 row_ror:8 row_mask:0xf bank_mask:0xf
    v_dot2c_f32_bf16_dpp v31, v85, v13 row_ror:8 row_mask:0xf bank_mask:0xf
    v_dot2c_f32_bf16_dpp v28, v74, v14 row_ror:8 row_mask:0xf bank_mask:0xf
    v_dot2c_f32_bf16_dpp v29, v78, v14 row_ror:8 row_mask:0xf bank_mask:0xf
    v_dot2c_f32_bf16_dpp v30, v82, v14 row_ror:8 row_mask:0xf bank_mask:0xf
    v_dot2c_f32_bf16_dpp v31, v86, v14 row_ror:8 row_mask:0xf bank_mask:0xf
    v_dot2c_f32_bf16_dpp v28, v75, v15 row_ror:8 row_mask:0xf bank_mask:0xf
    v_dot2c_f32_bf16_dpp v29, v79, v15 row_ror:8 row_mask:0xf bank_mask:0xf
    v_dot2c_f32_bf16_dpp v30, v83, v15 row_ror:8 row_mask:0xf bank_mask:0xf
    v_dot2c_f32_bf16_dpp v31, v87, v15 row_ror:8 row_mask:0xf bank_mask:0xf
    s_cmp_eq_u32 s45, 0
    s_nop 0
    s_cbranch_scc1 L_SK3
    s_xor_b32 s49, s48, 32768
    buffer_load_dwordx4 a[32:35], v2, s[36:39], s49 offen nt
    s_xor_b32 s49, s48, 36864
    buffer_load_dwordx4 a[36:39], v2, s[36:39], s49 offen nt
    s_branch L_SJ3
L_SK3:
    s_xor_b32 s49, s48, 114688
    buffer_load_dwordx4 v[72:75], v2, s[36:39], s49 offen nt
    s_xor_b32 s49, s48, 118784
    buffer_load_dwordx4 v[76:79], v2, s[36:39], s49 offen nt
    s_xor_b32 s49, s48, 122880
    buffer_load_dwordx4 v[80:83], v2, s[36:39], s49 offen nt
L_SJ3:
    v_add_f32_dpp v28, v28, v28 quad_perm:[1,0,3,2] row_mask:0xf bank_mask:0xf
    v_add_f32_dpp v29, v29, v29 quad_perm:[1,0,3,2] row_mask:0xf bank_mask:0xf
    v_add_f32_dpp v30, v30, v30 quad_perm:[1,0,3,2] row_mask:0xf bank_mask:0xf
    v_add_f32_dpp v31, v31, v31 quad_perm:[1,0,3,2] row_mask:0xf bank_mask:0xf
    v_add_f32_dpp v28, v28, v28 quad_perm:[2,3,0,1] row_mask:0xf bank_mask:0xf
    v_add_f32_dpp v29, v29, v29 quad_perm:[2,3,0,1] row_mask:0xf bank_mask:0xf
    v_add_f32_dpp v30, v30, v30 quad_perm:[2,3,0,1] row_mask:0xf bank_mask:0xf
    v_add_f32_dpp v31, v31, v31 quad_perm:[2,3,0,1] row_mask:0xf bank_mask:0xf
    v_add_f32_dpp v84, v28, v28 row_half_mirror row_mask:0xf bank_mask:0xf
    v_add_f32_dpp v85, v29, v29 row_half_mirror row_mask:0xf bank_mask:0xf
    v_add_f32_dpp v86, v30, v30 row_half_mirror row_mask:0xf bank_mask:0xf
    v_add_f32_dpp v87, v31, v31 row_half_mirror row_mask:0xf bank_mask:0xf
    v_cvt_pk_bf16_f32 v32, v84, v85
    v_cvt_pk_bf16_f32 v33, v86, v87
    v_lshlrev_b32 v84, 16, v32
    v_and_b32 v85, 0xffff0000, v32
    v_lshlrev_b32 v86, 16, v33
    v_and_b32 v87, 0xffff0000, v33
    v_mul_f32 v84, 0x3db504f3, v84
    v_mul_f32 v85, 0x3db504f3, v85
    v_mul_f32 v86, 0x3db504f3, v86
    v_mul_f32 v87, 0x3db504f3, v87
    v_cvt_pk_bf16_f32 v32, v84, v85
    v_cvt_pk_bf16_f32 v33, v86, v87
    v_lshlrev_b32 v84, 16, v32
    v_and_b32 v85, 0xffff0000, v32
    v_lshlrev_b32 v86, 16, v33
    v_and_b32 v87, 0xffff0000, v33
    v_max3_f32 v36, v36, v84, v85
    v_max3_f32 v36, v36, v86, v87
    s_waitcnt vmcnt(26)
    v_dot2_f32_bf16 v28, v88, v8, 0
    v_dot2_f32_bf16 v29, v92, v8, 0
    v_dot2_f32_bf16 v30, v96, v8, 0
    v_dot2_f32_bf16 v31, v100, v8, 0
    v_dot2c_f32_bf16 v28, v89, v9
    v_dot2c_f32_bf16 v29, v93, v9
    v_dot2c_f32_bf16 v30, v97, v9
    v_dot2c_f32_bf16 v31, v101, v9
    v_dot2c_f32_bf16 v28, v90, v10
    v_dot2c_f32_bf16 v29, v94, v10
    v_dot2c_f32_bf16 v30, v98, v10
    v_dot2c_f32_bf16 v31, v102, v10
    v_dot2c_f32_bf16 v28, v91, v11
    v_dot2c_f32_bf16 v29, v95, v11
    v_dot2c_f32_bf16 v30, v99, v11
    v_dot2c_f32_bf16 v31, v103, v11
    v_dot2c_f32_bf16_dpp v28, v88, v12 row_ror:8 row_mask:0xf bank_mask:0xf
    v_dot2c_f32_bf16_dpp v29, v92, v12 row_ror:8 row_mask:0xf bank_mask:0xf
    v_dot2c_f32_bf16_dpp v30, v96, v12 row_ror:8 row_mask:0xf bank_mask:0xf
    v_dot2c_f32_bf16_dpp v31, v100, v12 row_ror:8 row_mask:0xf bank_mask:0xf
    v_dot2c_f32_bf16_dpp v28, v89, v13 row_ror:8 row_mask:0xf bank_mask:0xf
    v_dot2c_f32_bf16_dpp v29, v93, v13 row_ror:8 row_mask:0xf bank_mask:0xf
    v_dot2c_f32_bf16_dpp v30, v97, v13 row_ror:8 row_mask:0xf bank_mask:0xf
    v_dot2c_f32_bf16_dpp v31, v101, v13 row_ror:8 row_mask:0xf bank_mask:0xf
    v_dot2c_f32_bf16_dpp v28, v90, v14 row_ror:8 row_mask:0xf bank_mask:0xf
    v_dot2c_f32_bf16_dpp v29, v94, v14 row_ror:8 row_mask:0xf bank_mask:0xf
    v_dot2c_f32_bf16_dpp v30, v98, v14 row_ror:8 row_mask:0xf bank_mask:0xf
    v_dot2c_f32_bf16_dpp v31, v102, v14 row_ror:8 row_mask:0xf bank_mask:0xf
    v_dot2c_f32_bf16_dpp v28, v91, v15 row_ror:8 row_mask:0xf bank_mask:0xf
    v_dot2c_f32_bf16_dpp v29, v95, v15 row_ror:8 row_mask:0xf bank_mask:0xf
    v_dot2c_f32_bf16_dpp v30, v99, v15 row_ror:8 row_mask:0xf bank_mask:0xf
    v_dot2c_f32_bf16_dpp v31, v103, v15 row_ror:8 row_mask:0xf bank_mask:0xf
    s_cmp_eq_u32 s45, 0
    s_nop 0
    s_cbranch_scc1 L_SK4
    s_xor_b32 s49, s48, 40960
    buffer_load_dwordx4 a[40:43], v2, s[36:39], s49 offen nt
    s_xor_b32 s49, s48, 45056
    buffer_load_dwordx4 a[44:47], v2, s[36:39], s49 offen nt
    s_branch L_SJ4
L_SK4:
    s_xor_b32 s49, s48, 126976
    buffer_load_dwordx4 v[88:91], v2, s[36:39], s49 offen nt
L_SJ4:
    v_add_f32_dpp v28, v28, v28 quad_perm:[1,0,3,2] row_mask:0xf bank_mask:0xf
    v_add_f32_dpp v29, v29, v29 quad_perm:[1,0,3,2] row_mask:0xf bank_mask:0xf
    v_add_f32_dpp v30, v30, v30 quad_perm:[1,0,3,2] row_mask:0xf bank_mask:0xf
    v_add_f32_dpp v31, v31, v31 quad_perm:[1,0,3,2] row_mask:0xf bank_mask:0xf
    v_add_f32_dpp v28, v28, v28 quad_perm:[2,3,0,1] row_mask:0xf bank_mask:0xf
    v_add_f32_dpp v29, v29, v29 quad_perm:[2,3,0,1] row_mask:0xf bank_mask:0xf
    v_add_f32_dpp v30, v30, v30 quad_perm:[2,3,0,1] row_mask:0xf bank_mask:0xf
    v_add_f32_dpp v31, v31, v31 quad_perm:[2,3,0,1] row_mask:0xf bank_mask:0xf
    v_add_f32_dpp v100, v28, v28 row_half_mirror row_mask:0xf bank_mask:0xf
    v_add_f32_dpp v101, v29, v29 row_half_mirror row_mask:0xf bank_mask:0xf
    v_add_f32_dpp v102, v30, v30 row_half_mirror row_mask:0xf bank_mask:0xf
    v_add_f32_dpp v103, v31, v31 row_half_mirror row_mask:0xf bank_mask:0xf
    v_cvt_pk_bf16_f32 v32, v100, v101
    v_cvt_pk_bf16_f32 v33, v102, v103
    v_lshlrev_b32 v100, 16, v32
    v_and_b32 v101, 0xffff0000, v32
    v_lshlrev_b32 v102, 16, v33
    v_and_b32 v103, 0xffff0000, v33
    v_mul_f32 v100, 0x3db504f3, v100
    v_mul_f32 v101, 0x3db504f3, v101
    v_mul_f32 v102, 0x3db504f3, v102
    v_mul_f32 v103, 0x3db504f3, v103
    v_cvt_pk_bf16_f32 v32, v100, v101
    v_cvt_pk_bf16_f32 v33, v102, v103
    v_lshlrev_b32 v100, 16, v32
    v_and_b32 v101, 0xffff0000, v32
    v_lshlrev_b32 v102, 16, v33
    v_and_b32 v103, 0xffff0000, v33
    v_max3_f32 v36, v36, v100, v101
    v_max3_f32 v36, v36, v102, v103
    s_waitcnt vmcnt(24)
    v_dot2_f32_bf16 v28, v104, v8, 0
    v_dot2_f32_bf16 v29, v108, v8, 0
    v_dot2_f32_bf16 v30, v112, v8, 0
    v_dot2_f32_bf16 v31, v116, v8, 0
    v_dot2c_f32_bf16 v28, v105, v9
    v_dot2c_f32_bf16 v29, v109, v9
    v_dot2c_f32_bf16 v30, v113, v9
    v_dot2c_f32_bf16 v31, v117, v9
    v_dot2c_f32_bf16 v28, v106, v10
    v_dot2c_f32_bf16 v29, v110, v10
    v_dot2c_f32_bf16 v30, v114, v10
    v_dot2c_f32_bf16 v31, v118, v10
    v_dot2c_f32_bf16 v28, v107, v11
    v_dot2c_f32_bf16 v29, v111, v11
    v_dot2c_f32_bf16 v30, v115, v11
    v_dot2c_f32_bf16 v31, v119, v11
    v_dot2c_f32_bf16_dpp v28, v104, v12 row_ror:8 row_mask:0xf bank_mask:0xf
    v_dot2c_f32_bf16_dpp v29, v108, v12 row_ror:8 row_mask:0xf bank_mask:0xf
    v_dot2c_f32_bf16_dpp v30, v112, v12 row_ror:8 row_mask:0xf bank_mask:0xf
    v_dot2c_f32_bf16_dpp v31, v116, v12 row_ror:8 row_mask:0xf bank_mask:0xf
    v_dot2c_f32_bf16_dpp v28, v105, v13 row_ror:8 row_mask:0xf bank_mask:0xf
    v_dot2c_f32_bf16_dpp v29, v109, v13 row_ror:8 row_mask:0xf bank_mask:0xf
    v_dot2c_f32_bf16_dpp v30, v113, v13 row_ror:8 row_mask:0xf bank_mask:0xf
    v_dot2c_f32_bf16_dpp v31, v117, v13 row_ror:8 row_mask:0xf bank_mask:0xf
    v_dot2c_f32_bf16_dpp v28, v106, v14 row_ror:8 row_mask:0xf bank_mask:0xf
    v_dot2c_f32_bf16_dpp v29, v110, v14 row_ror:8 row_mask:0xf bank_mask:0xf
    v_dot2c_f32_bf16_dpp v30, v114, v14 row_ror:8 row_mask:0xf bank_mask:0xf
    v_dot2c_f32_bf16_dpp v31, v118, v14 row_ror:8 row_mask:0xf bank_mask:0xf
    v_dot2c_f32_bf16_dpp v28, v107, v15 row_ror:8 row_mask:0xf bank_mask:0xf
    v_dot2c_f32_bf16_dpp v29, v111, v15 row_ror:8 row_mask:0xf bank_mask:0xf
    v_dot2c_f32_bf16_dpp v30, v115, v15 row_ror:8 row_mask:0xf bank_mask:0xf
    v_dot2c_f32_bf16_dpp v31, v119, v15 row_ror:8 row_mask:0xf bank_mask:0xf
    s_cmp_eq_u32 s45, 0
    s_nop 0
    s_cbranch_scc1 L_SK5
    s_xor_b32 s49, s48, 49152
    buffer_load_dwordx4 a[48:51], v2, s[36:39], s49 offen nt
    s_xor_b32 s49, s48, 53248
    buffer_load_dwordx4 a[52:55], v2, s[36:39], s49 offen nt
L_SK5:
    v_add_f32_dpp v28, v28, v28 quad_perm:[1,0,3,2] row_mask:0xf bank_mask:0xf
    v_add_f32_dpp v29, v29, v29 quad_perm:[1,0,3,2] row_mask:0xf bank_mask:0xf
    v_add_f32_dpp v30, v30, v30 quad_perm:[1,0,3,2] row_mask:0xf bank_mask:0xf
    v_add_f32_dpp v31, v31, v31 quad_perm:[1,0,3,2] row_mask:0xf bank_mask:0xf
    v_add_f32_dpp v28, v28, v28 quad_perm:[2,3,0,1] row_mask:0xf bank_mask:0xf
    v_add_f32_dpp v29, v29, v29 quad_perm:[2,3,0,1] row_mask:0xf bank_mask:0xf
    v_add_f32_dpp v30, v30, v30 quad_perm:[2,3,0,1] row_mask:0xf bank_mask:0xf
    v_add_f32_dpp v31, v31, v31 quad_perm:[2,3,0,1] row_mask:0xf bank_mask:0xf
    v_add_f32_dpp v116, v28, v28 row_half_mirror row_mask:0xf bank_mask:0xf
    v_add_f32_dpp v117, v29, v29 row_half_mirror row_mask:0xf bank_mask:0xf
    v_add_f32_dpp v118, v30, v30 row_half_mirror row_mask:0xf bank_mask:0xf
    v_add_f32_dpp v119, v31, v31 row_half_mirror row_mask:0xf bank_mask:0xf
    v_cvt_pk_bf16_f32 v32, v116, v117
    v_cvt_pk_bf16_f32 v33, v118, v119
    v_lshlrev_b32 v116, 16, v32
    v_and_b32 v117, 0xffff0000, v32
    v_lshlrev_b32 v118, 16, v33
    v_and_b32 v119, 0xffff0000, v33
    v_mul_f32 v116, 0x3db504f3, v116
    v_mul_f32 v117, 0x3db504f3, v117
    v_mul_f32 v118, 0x3db504f3, v118
    v_mul_f32 v119, 0x3db504f3, v119
    v_cvt_pk_bf16_f32 v32, v116, v117
    v_cvt_pk_bf16_f32 v33, v118, v119
    v_lshlrev_b32 v116, 16, v32
    v_and_b32 v117, 0xffff0000, v32
    v_lshlrev_b32 v118, 16, v33
    v_and_b32 v119, 0xffff0000, v33
    v_max3_f32 v36, v36, v116, v117
    v_max3_f32 v36, v36, v118, v119
    s_waitcnt vmcnt(22)
    v_dot2_f32_bf16 v28, v120, v8, 0
    v_dot2_f32_bf16 v29, v124, v8, 0
    v_dot2_f32_bf16 v30, v128, v8, 0
    v_dot2_f32_bf16 v31, v132, v8, 0
    v_dot2c_f32_bf16 v28, v121, v9
    v_dot2c_f32_bf16 v29, v125, v9
    v_dot2c_f32_bf16 v30, v129, v9
    v_dot2c_f32_bf16 v31, v133, v9
    v_dot2c_f32_bf16 v28, v122, v10
    v_dot2c_f32_bf16 v29, v126, v10
    v_dot2c_f32_bf16 v30, v130, v10
    v_dot2c_f32_bf16 v31, v134, v10
    v_dot2c_f32_bf16 v28, v123, v11
    v_dot2c_f32_bf16 v29, v127, v11
    v_dot2c_f32_bf16 v30, v131, v11
    v_dot2c_f32_bf16 v31, v135, v11
    v_dot2c_f32_bf16_dpp v28, v120, v12 row_ror:8 row_mask:0xf bank_mask:0xf
    v_dot2c_f32_bf16_dpp v29, v124, v12 row_ror:8 row_mask:0xf bank_mask:0xf
    v_dot2c_f32_bf16_dpp v30, v128, v12 row_ror:8 row_mask:0xf bank_mask:0xf
    v_dot2c_f32_bf16_dpp v31, v132, v12 row_ror:8 row_mask:0xf bank_mask:0xf
    v_dot2c_f32_bf16_dpp v28, v121, v13 row_ror:8 row_mask:0xf bank_mask:0xf
    v_dot2c_f32_bf16_dpp v29, v125, v13 row_ror:8 row_mask:0xf bank_mask:0xf
    v_dot2c_f32_bf16_dpp v30, v129, v13 row_ror:8 row_mask:0xf bank_mask:0xf
    v_dot2c_f32_bf16_dpp v31, v133, v13 row_ror:8 row_mask:0xf bank_mask:0xf
    v_dot2c_f32_bf16_dpp v28, v122, v14 row_ror:8 row_mask:0xf bank_mask:0xf
    v_dot2c_f32_bf16_dpp v29, v126, v14 row_ror:8 row_mask:0xf bank_mask:0xf
    v_dot2c_f32_bf16_dpp v30, v130, v14 row_ror:8 row_mask:0xf bank_mask:0xf
    v_dot2c_f32_bf16_dpp v31, v134, v14 row_ror:8 row_mask:0xf bank_mask:0xf
    v_dot2c_f32_bf16_dpp v28, v123, v15 row_ror:8 row_mask:0xf bank_mask:0xf
    v_dot2c_f32_bf16_dpp v29, v127, v15 row_ror:8 row_mask:0xf bank_mask:0xf
    v_dot2c_f32_bf16_dpp v30, v131, v15 row_ror:8 row_mask:0xf bank_mask:0xf
    v_dot2c_f32_bf16_dpp v31, v135, v15 row_ror:8 row_mask:0xf bank_mask:0xf
    s_cmp_eq_u32 s45, 0
    s_nop 0
    s_cbranch_scc1 L_SK6
    s_xor_b32 s49, s48, 57344
    buffer_load_dwordx4 a[56:59], v2, s[36:39], s49 offen nt
    s_xor_b32 s49, s48, 61440
    buffer_load_dwordx4 a[60:63], v2, s[36:39], s49 offen nt
L_SK6:
    v_add_f32_dpp v28, v28, v28 quad_perm:[1,0,3,2] row_mask:0xf bank_mask:0xf
    v_add_f32_dpp v29, v29, v29 quad_perm:[1,0,3,2] row_mask:0xf bank_mask:0xf
    v_add_f32_dpp v30, v30, v30 quad_perm:[1,0,3,2] row_mask:0xf bank_mask:0xf
    v_add_f32_dpp v31, v31, v31 quad_perm:[1,0,3,2] row_mask:0xf bank_mask:0xf
    v_add_f32_dpp v28, v28, v28 quad_perm:[2,3,0,1] row_mask:0xf bank_mask:0xf
    v_add_f32_dpp v29, v29, v29 quad_perm:[2,3,0,1] row_mask:0xf bank_mask:0xf
    v_add_f32_dpp v30, v30, v30 quad_perm:[2,3,0,1] row_mask:0xf bank_mask:0xf
    v_add_f32_dpp v31, v31, v31 quad_perm:[2,3,0,1] row_mask:0xf bank_mask:0xf
    v_add_f32_dpp v132, v28, v28 row_half_mirror row_mask:0xf bank_mask:0xf
    v_add_f32_dpp v133, v29, v29 row_half_mirror row_mask:0xf bank_mask:0xf
    v_add_f32_dpp v134, v30, v30 row_half_mirror row_mask:0xf bank_mask:0xf
    v_add_f32_dpp v135, v31, v31 row_half_mirror row_mask:0xf bank_mask:0xf
    v_cvt_pk_bf16_f32 v32, v132, v133
    v_cvt_pk_bf16_f32 v33, v134, v135
    v_lshlrev_b32 v132, 16, v32
    v_and_b32 v133, 0xffff0000, v32
    v_lshlrev_b32 v134, 16, v33
    v_and_b32 v135, 0xffff0000, v33
    v_mul_f32 v132, 0x3db504f3, v132
    v_mul_f32 v133, 0x3db504f3, v133
    v_mul_f32 v134, 0x3db504f3, v134
    v_mul_f32 v135, 0x3db504f3, v135
    v_cvt_pk_bf16_f32 v32, v132, v133
    v_cvt_pk_bf16_f32 v33, v134, v135
    v_lshlrev_b32 v132, 16, v32
    v_and_b32 v133, 0xffff0000, v32
    v_lshlrev_b32 v134, 16, v33
    v_and_b32 v135, 0xffff0000, v33
    v_max3_f32 v36, v36, v132, v133
    v_max3_f32 v36, v36, v134, v135
    s_waitcnt vmcnt(20)
    v_dot2_f32_bf16 v28, v136, v8, 0
    v_dot2_f32_bf16 v29, v140, v8, 0
    v_dot2_f32_bf16 v30, v144, v8, 0
    v_dot2_f32_bf16 v31, v148, v8, 0
    v_dot2c_f32_bf16 v28, v137, v9
    v_dot2c_f32_bf16 v29, v141, v9
    v_dot2c_f32_bf16 v30, v145, v9
    v_dot2c_f32_bf16 v31, v149, v9
    v_dot2c_f32_bf16 v28, v138, v10
    v_dot2c_f32_bf16 v29, v142, v10
    v_dot2c_f32_bf16 v30, v146, v10
    v_dot2c_f32_bf16 v31, v150, v10
    v_dot2c_f32_bf16 v28, v139, v11
    v_dot2c_f32_bf16 v29, v143, v11
    v_dot2c_f32_bf16 v30, v147, v11
    v_dot2c_f32_bf16 v31, v151, v11
    v_dot2c_f32_bf16_dpp v28, v136, v12 row_ror:8 row_mask:0xf bank_mask:0xf
    v_dot2c_f32_bf16_dpp v29, v140, v12 row_ror:8 row_mask:0xf bank_mask:0xf
    v_dot2c_f32_bf16_dpp v30, v144, v12 row_ror:8 row_mask:0xf bank_mask:0xf
    v_dot2c_f32_bf16_dpp v31, v148, v12 row_ror:8 row_mask:0xf bank_mask:0xf
    v_dot2c_f32_bf16_dpp v28, v137, v13 row_ror:8 row_mask:0xf bank_mask:0xf
    v_dot2c_f32_bf16_dpp v29, v141, v13 row_ror:8 row_mask:0xf bank_mask:0xf
    v_dot2c_f32_bf16_dpp v30, v145, v13 row_ror:8 row_mask:0xf bank_mask:0xf
    v_dot2c_f32_bf16_dpp v31, v149, v13 row_ror:8 row_mask:0xf bank_mask:0xf
    v_dot2c_f32_bf16_dpp v28, v138, v14 row_ror:8 row_mask:0xf bank_mask:0xf
    v_dot2c_f32_bf16_dpp v29, v142, v14 row_ror:8 row_mask:0xf bank_mask:0xf
    v_dot2c_f32_bf16_dpp v30, v146, v14 row_ror:8 row_mask:0xf bank_mask:0xf
    v_dot2c_f32_bf16_dpp v31, v150, v14 row_ror:8 row_mask:0xf bank_mask:0xf
    v_dot2c_f32_bf16_dpp v28, v139, v15 row_ror:8 row_mask:0xf bank_mask:0xf
    v_dot2c_f32_bf16_dpp v29, v143, v15 row_ror:8 row_mask:0xf bank_mask:0xf
    v_dot2c_f32_bf16_dpp v30, v147, v15 row_ror:8 row_mask:0xf bank_mask:0xf
    v_dot2c_f32_bf16_dpp v31, v151, v15 row_ror:8 row_mask:0xf bank_mask:0xf
    s_cmp_eq_u32 s45, 0
    s_nop 0
    s_cbranch_scc1 L_SK7
    s_xor_b32 s49, s48, 65536
    buffer_load_dwordx4 a[64:67], v2, s[36:39], s49 offen nt
    s_xor_b32 s49, s48, 69632
    buffer_load_dwordx4 a[68:71], v2, s[36:39], s49 offen nt
L_SK7:
    v_add_f32_dpp v28, v28, v28 quad_perm:[1,0,3,2] row_mask:0xf bank_mask:0xf
    v_add_f32_dpp v29, v29, v29 quad_perm:[1,0,3,2] row_mask:0xf bank_mask:0xf
    v_add_f32_dpp v30, v30, v30 quad_perm:[1,0,3,2] row_mask:0xf bank_mask:0xf
    v_add_f32_dpp v31, v31, v31 quad_perm:[1,0,3,2] row_mask:0xf bank_mask:0xf
    v_add_f32_dpp v28, v28, v28 quad_perm:[2,3,0,1] row_mask:0xf bank_mask:0xf
    v_add_f32_dpp v29, v29, v29 quad_perm:[2,3,0,1] row_mask:0xf bank_mask:0xf
    v_add_f32_dpp v30, v30, v30 quad_perm:[2,3,0,1] row_mask:0xf bank_mask:0xf
    v_add_f32_dpp v31, v31, v31 quad_perm:[2,3,0,1] row_mask:0xf bank_mask:0xf
    v_add_f32_dpp v148, v28, v28 row_half_mirror row_mask:0xf bank_mask:0xf
    v_add_f32_dpp v149, v29, v29 row_half_mirror row_mask:0xf bank_mask:0xf
    v_add_f32_dpp v150, v30, v30 row_half_mirror row_mask:0xf bank_mask:0xf
    v_add_f32_dpp v151, v31, v31 row_half_mirror row_mask:0xf bank_mask:0xf
    v_cvt_pk_bf16_f32 v32, v148, v149
    v_cvt_pk_bf16_f32 v33, v150, v151
    v_lshlrev_b32 v148, 16, v32
    v_and_b32 v149, 0xffff0000, v32
    v_lshlrev_b32 v150, 16, v33
    v_and_b32 v151, 0xffff0000, v33
    v_mul_f32 v148, 0x3db504f3, v148
    v_mul_f32 v149, 0x3db504f3, v149
    v_mul_f32 v150, 0x3db504f3, v150
    v_mul_f32 v151, 0x3db504f3, v151
    v_cvt_pk_bf16_f32 v32, v148, v149
    v_cvt_pk_bf16_f32 v33, v150, v151
    v_lshlrev_b32 v148, 16, v32
    v_and_b32 v149, 0xffff0000, v32
    v_lshlrev_b32 v150, 16, v33
    v_and_b32 v151, 0xffff0000, v33
    v_max3_f32 v36, v36, v148, v149
    v_max3_f32 v36, v36, v150, v151
    s_waitcnt vmcnt(18)
    v_dot2_f32_bf16 v28, v152, v8, 0
    v_dot2_f32_bf16 v29, v156, v8, 0
    v_dot2_f32_bf16 v30, v160, v8, 0
    v_dot2_f32_bf16 v31, v164, v8, 0
    v_dot2c_f32_bf16 v28, v153, v9
    v_dot2c_f32_bf16 v29, v157, v9
    v_dot2c_f32_bf16 v30, v161, v9
    v_dot2c_f32_bf16 v31, v165, v9
    v_dot2c_f32_bf16 v28, v154, v10
    v_dot2c_f32_bf16 v29, v158, v10
    v_dot2c_f32_bf16 v30, v162, v10
    v_dot2c_f32_bf16 v31, v166, v10
    v_dot2c_f32_bf16 v28, v155, v11
    v_dot2c_f32_bf16 v29, v159, v11
    v_dot2c_f32_bf16 v30, v163, v11
    v_dot2c_f32_bf16 v31, v167, v11
    v_dot2c_f32_bf16_dpp v28, v152, v12 row_ror:8 row_mask:0xf bank_mask:0xf
    v_dot2c_f32_bf16_dpp v29, v156, v12 row_ror:8 row_mask:0xf bank_mask:0xf
    v_dot2c_f32_bf16_dpp v30, v160, v12 row_ror:8 row_mask:0xf bank_mask:0xf
    v_dot2c_f32_bf16_dpp v31, v164, v12 row_ror:8 row_mask:0xf bank_mask:0xf
    v_dot2c_f32_bf16_dpp v28, v153, v13 row_ror:8 row_mask:0xf bank_mask:0xf
    v_dot2c_f32_bf16_dpp v29, v157, v13 row_ror:8 row_mask:0xf bank_mask:0xf
    v_dot2c_f32_bf16_dpp v30, v161, v13 row_ror:8 row_mask:0xf bank_mask:0xf
    v_dot2c_f32_bf16_dpp v31, v165, v13 row_ror:8 row_mask:0xf bank_mask:0xf
    v_dot2c_f32_bf16_dpp v28, v154, v14 row_ror:8 row_mask:0xf bank_mask:0xf
    v_dot2c_f32_bf16_dpp v29, v158, v14 row_ror:8 row_mask:0xf bank_mask:0xf
    v_dot2c_f32_bf16_dpp v30, v162, v14 row_ror:8 row_mask:0xf bank_mask:0xf
    v_dot2c_f32_bf16_dpp v31, v166, v14 row_ror:8 row_mask:0xf bank_mask:0xf
    v_dot2c_f32_bf16_dpp v28, v155, v15 row_ror:8 row_mask:0xf bank_mask:0xf
    v_dot2c_f32_bf16_dpp v29, v159, v15 row_ror:8 row_mask:0xf bank_mask:0xf
    v_dot2c_f32_bf16_dpp v30, v163, v15 row_ror:8 row_mask:0xf bank_mask:0xf
    v_dot2c_f32_bf16_dpp v31, v167, v15 row_ror:8 row_mask:0xf bank_mask:0xf
    s_cmp_eq_u32 s45, 0
    s_nop 0
    s_cbranch_scc1 L_SK8
    s_xor_b32 s49, s48, 73728
    buffer_load_dwordx4 a[72:75], v2, s[36:39], s49 offen nt
    s_xor_b32 s49, s48, 77824
    buffer_load_dwordx4 a[76:79], v2, s[36:39], s49 offen nt
L_SK8:
    v_add_f32_dpp v28, v28, v28 quad_perm:[1,0,3,2] row_mask:0xf bank_mask:0xf
    v_add_f32_dpp v29, v29, v29 quad_perm:[1,0,3,2] row_mask:0xf bank_mask:0xf
    v_add_f32_dpp v30, v30, v30 quad_perm:[1,0,3,2] row_mask:0xf bank_mask:0xf
    v_add_f32_dpp v31, v31, v31 quad_perm:[1,0,3,2] row_mask:0xf bank_mask:0xf
    v_add_f32_dpp v28, v28, v28 quad_perm:[2,3,0,1] row_mask:0xf bank_mask:0xf
    v_add_f32_dpp v29, v29, v29 quad_perm:[2,3,0,1] row_mask:0xf bank_mask:0xf
    v_add_f32_dpp v30, v30, v30 quad_perm:[2,3,0,1] row_mask:0xf bank_mask:0xf
    v_add_f32_dpp v31, v31, v31 quad_perm:[2,3,0,1] row_mask:0xf bank_mask:0xf
    v_add_f32_dpp v164, v28, v28 row_half_mirror row_mask:0xf bank_mask:0xf
    v_add_f32_dpp v165, v29, v29 row_half_mirror row_mask:0xf bank_mask:0xf
    v_add_f32_dpp v166, v30, v30 row_half_mirror row_mask:0xf bank_mask:0xf
    v_add_f32_dpp v167, v31, v31 row_half_mirror row_mask:0xf bank_mask:0xf
    v_cvt_pk_bf16_f32 v32, v164, v165
    v_cvt_pk_bf16_f32 v33, v166, v167
    v_lshlrev_b32 v164, 16, v32
    v_and_b32 v165, 0xffff0000, v32
    v_lshlrev_b32 v166, 16, v33
    v_and_b32 v167, 0xffff0000, v33
    v_mul_f32 v164, 0x3db504f3, v164
    v_mul_f32 v165, 0x3db504f3, v165
    v_mul_f32 v166, 0x3db504f3, v166
    v_mul_f32 v167, 0x3db504f3, v167
    v_cvt_pk_bf16_f32 v32, v164, v165
    v_cvt_pk_bf16_f32 v33, v166, v167
    v_lshlrev_b32 v164, 16, v32
    v_and_b32 v165, 0xffff0000, v32
    v_lshlrev_b32 v166, 16, v33
    v_and_b32 v167, 0xffff0000, v33
    v_max3_f32 v36, v36, v164, v165
    v_max3_f32 v36, v36, v166, v167
    v_mov_b32 v28, v36
    s_nop 1
    v_permlane16_swap_b32 v28, v36
    v_max_f32 v36, v28, v36
    v_mov_b32 v28, v36
    s_nop 1
    v_permlane32_swap_b32 v28, v36
    v_max_f32 v36, v28, v36
    v_mul_f32 v36, s54, v36
    s_cmp_lt_u32 s40, 5
    s_cbranch_scc1 L_NOY
    v_mov_b32 v31, 32
    s_mov_b32 s52, 131072
    s_nop 0
L_AOK:
    ds_read_b32 v28, v31
    s_waitcnt lgkmcnt(0)
    v_readfirstlane_b32 s50, v28
    s_nop 0
    s_cmp_lg_u32 s50, 0
    s_cbranch_scc1 L_AOK_OK
    s_sleep 2
    s_sub_u32 s52, s52, 1
    s_cmp_lg_u32 s52, 0
    s_cbranch_scc1 L_AOK
L_AOK_OK:
    s_mov_b32 s75, s50
    s_sub_u32 s51, s40, 5
    s_mul_i32 s52, s51, 6
    v_and_b32 v29, 7, v1
    v_min_u32 v29, 5, v29
    v_add_u32 v29, s52, v29
    v_cmp_le_u32 vcc, 9, v29
    s_nop 1
    v_cndmask_b32 v30, 0, 3, vcc
    v_add_u32 v29, v29, v30
    v_lshlrev_b32 v28, 5, v29
    v_lshrrev_b32 v29, 3, v1
    v_lshl_add_u32 v28, v29, 2, v28
    s_add_u32 s50, s30, 688128
    v_add_u32 v28, s50, v28
    s_add_u32 s51, s51, 21
    v_lshrrev_b32 v29, s51, v0
    v_bfi_b32 v3, 1, v29, v3
    s_mov_b32 exec_lo, 0x3f3f3f3f
    s_mov_b32 exec_hi, 0x3f3f3f3f
    s_cmp_eq_u32 s75, 1
    s_cbranch_scc1 L_YF
    global_store_dword v28, v3, s[28:29] sc1
    s_branch L_YJ
L_YF:
    global_store_dword v28, v3, s[28:29]
L_YJ:
    s_mov_b64 exec, -1
L_NOY:
    v_mov_b32 v37, 0
    v_fma_f32 v52, v52, s54, -v36
    v_fma_f32 v53, v53, s54, -v36
    v_fma_f32 v54, v54, s54, -v36
    v_fma_f32 v55, v55, s54, -v36
    v_exp_f32 v52, v52
    v_exp_f32 v53, v53
    v_exp_f32 v54, v54
    v_exp_f32 v55, v55
    v_add_f32 v37, v37, v52
    v_add_f32 v37, v37, v53
    v_add_f32 v37, v37, v54
    v_add_f32 v37, v37, v55
    v_cvt_pk_bf16_f32 v52, v52, v52
    v_cvt_pk_bf16_f32 v53, v53, v53
    v_cvt_pk_bf16_f32 v54, v54, v54
    v_cvt_pk_bf16_f32 v55, v55, v55
    s_cmp_eq_u32 s45, 0
    s_cbranch_scc1 L_SK9
    s_xor_b32 s49, s48, 81920
    buffer_load_dwordx4 a[80:83], v2, s[36:39], s49 offen nt
L_SK9:
    v_fma_f32 v68, v68, s54, -v36
    v_fma_f32 v69, v69, s54, -v36
    v_fma_f32 v70, v70, s54, -v36
    v_fma_f32 v71, v71, s54, -v36
    v_exp_f32 v68, v68
    v_exp_f32 v69, v69
    v_exp_f32 v70, v70
    v_exp_f32 v71, v71
    v_add_f32 v37, v37, v68
    v_add_f32 v37, v37, v69
    v_add_f32 v37, v37, v70
    v_add_f32 v37, v37, v71
    v_cvt_pk_bf16_f32 v68, v68, v68
    v_cvt_pk_bf16_f32 v69, v69, v69
    v_cvt_pk_bf16_f32 v70, v70, v70
    v_cvt_pk_bf16_f32 v71, v71, v71
    s_cmp_eq_u32 s45, 0
    s_cbranch_scc1 L_SK10
    s_xor_b32 s49, s48, 86016
    buffer_load_dwordx4 a[84:87], v2, s[36:39], s49 offen nt
L_SK10:
    v_fma_f32 v84, v84, s54, -v36
    v_fma_f32 v85, v85, s54, -v36
    v_fma_f32 v86, v86, s54, -v36
    v_fma_f32 v87, v87, s54, -v36
    v_exp_f32 v84, v84
    v_exp_f32 v85, v85
    v_exp_f32 v86, v86
    v_exp_f32 v87, v87
    v_add_f32 v37, v37, v84
    v_add_f32 v37, v37, v85
    v_add_f32 v37, v37, v86
    v_add_f32 v37, v37, v87
    v_cvt_pk_bf16_f32 v84, v84, v84
    v_cvt_pk_bf16_f32 v85, v85, v85
    v_cvt_pk_bf16_f32 v86, v86, v86
    v_cvt_pk_bf16_f32 v87, v87, v87
    s_cmp_eq_u32 s45, 0
    s_cbranch_scc1 L_SK11
    s_xor_b32 s49, s48, 90112
    buffer_load_dwordx4 v[40:43], v2, s[36:39], s49 offen nt
L_SK11:
    v_fma_f32 v100, v100, s54, -v36
    v_fma_f32 v101, v101, s54, -v36
    v_fma_f32 v102, v102, s54, -v36
    v_fma_f32 v103, v103, s54, -v36
    v_exp_f32 v100, v100
    v_exp_f32 v101, v101
    v_exp_f32 v102, v102
    v_exp_f32 v103, v103
    v_add_f32 v37, v37, v100
    v_add_f32 v37, v37, v101
    v_add_f32 v37, v37, v102
    v_add_f32 v37, v37, v103
    v_cvt_pk_bf16_f32 v100, v100, v100
    v_cvt_pk_bf16_f32 v101, v101, v101
    v_cvt_pk_bf16_f32 v102, v102, v102
    v_cvt_pk_bf16_f32 v103, v103, v103
    s_cmp_eq_u32 s45, 0
    s_cbranch_scc1 L_SK12
    s_xor_b32 s49, s48, 94208
    buffer_load_dwordx4 v[44:47], v2, s[36:39], s49 offen nt
L_SK12:
    v_fma_f32 v116, v116, s54, -v36
    v_fma_f32 v117, v117, s54, -v36
    v_fma_f32 v118, v118, s54, -v36
    v_fma_f32 v119, v119, s54, -v36
    v_exp_f32 v116, v116
    v_exp_f32 v117, v117
    v_exp_f32 v118, v118
    v_exp_f32 v119, v119
    v_add_f32 v37, v37, v116
    v_add_f32 v37, v37, v117
    v_add_f32 v37, v37, v118
    v_add_f32 v37, v37, v119
    v_cvt_pk_bf16_f32 v116, v116, v116
    v_cvt_pk_bf16_f32 v117, v117, v117
    v_cvt_pk_bf16_f32 v118, v118, v118
    v_cvt_pk_bf16_f32 v119, v119, v119
    s_cmp_eq_u32 s45, 0
    s_cbranch_scc1 L_SK13
    s_xor_b32 s49, s48, 98304
    buffer_load_dwordx4 v[48:51], v2, s[36:39], s49 offen nt
L_SK13:
    v_fma_f32 v132, v132, s54, -v36
    v_fma_f32 v133, v133, s54, -v36
    v_fma_f32 v134, v134, s54, -v36
    v_fma_f32 v135, v135, s54, -v36
    v_exp_f32 v132, v132
    v_exp_f32 v133, v133
    v_exp_f32 v134, v134
    v_exp_f32 v135, v135
    v_add_f32 v37, v37, v132
    v_add_f32 v37, v37, v133
    v_add_f32 v37, v37, v134
    v_add_f32 v37, v37, v135
    v_cvt_pk_bf16_f32 v132, v132, v132
    v_cvt_pk_bf16_f32 v133, v133, v133
    v_cvt_pk_bf16_f32 v134, v134, v134
    v_cvt_pk_bf16_f32 v135, v135, v135
    s_cmp_eq_u32 s45, 0
    s_cbranch_scc1 L_SK14
    s_xor_b32 s49, s48, 102400
    buffer_load_dwordx4 v[56:59], v2, s[36:39], s49 offen nt
L_SK14:
    v_fma_f32 v148, v148, s54, -v36
    v_fma_f32 v149, v149, s54, -v36
    v_fma_f32 v150, v150, s54, -v36
    v_fma_f32 v151, v151, s54, -v36
    v_exp_f32 v148, v148
    v_exp_f32 v149, v149
    v_exp_f32 v150, v150
    v_exp_f32 v151, v151
    v_add_f32 v37, v37, v148
    v_add_f32 v37, v37, v149
    v_add_f32 v37, v37, v150
    v_add_f32 v37, v37, v151
    v_cvt_pk_bf16_f32 v148, v148, v148
    v_cvt_pk_bf16_f32 v149, v149, v149
    v_cvt_pk_bf16_f32 v150, v150, v150
    v_cvt_pk_bf16_f32 v151, v151, v151
    s_cmp_eq_u32 s45, 0
    s_cbranch_scc1 L_SK15
    s_xor_b32 s49, s48, 106496
    buffer_load_dwordx4 v[60:63], v2, s[36:39], s49 offen nt
L_SK15:
    v_fma_f32 v164, v164, s54, -v36
    v_fma_f32 v165, v165, s54, -v36
    v_fma_f32 v166, v166, s54, -v36
    v_fma_f32 v167, v167, s54, -v36
    v_exp_f32 v164, v164
    v_exp_f32 v165, v165
    v_exp_f32 v166, v166
    v_exp_f32 v167, v167
    v_add_f32 v37, v37, v164
    v_add_f32 v37, v37, v165
    v_add_f32 v37, v37, v166
    v_add_f32 v37, v37, v167
    v_cvt_pk_bf16_f32 v164, v164, v164
    v_cvt_pk_bf16_f32 v165, v165, v165
    v_cvt_pk_bf16_f32 v166, v166, v166
    v_cvt_pk_bf16_f32 v167, v167, v167
    s_cmp_eq_u32 s45, 0
    s_cbranch_scc1 L_SK16
    s_xor_b32 s49, s48, 110592
    buffer_load_dwordx4 v[64:67], v2, s[36:39], s49 offen nt
L_SK16:
    v_mov_b32 v28, v37
    s_nop 1
    v_permlane16_swap_b32 v28, v37
    v_add_f32 v37, v28, v37
    v_mov_b32 v28, v37
    s_nop 1
    v_permlane32_swap_b32 v28, v37
    v_add_f32 v37, v28, v37
    v_bfe_u32 v35, v1, 3, 1
    v_lshlrev_b32 v34, 6, v35
    s_lshl_b32 s50, s40, 3
    v_add_u32 v28, s50, v34
    v_mov_b32 v30, 1
    v_mov_b32 v31, 8
    s_mov_b64 exec, 0x101
    ds_write_b64 v28, v[36:37] offset:64
    s_mov_b64 exec, 1
    ds_add_rtn_u32 v32, v31, v30
    s_mov_b64 exec, -1
    v_lshlrev_b32 v36, 8, v35
    v_lshrrev_b32 v29, 4, v1
    v_lshl_add_u32 v36, v29, 6, v36
    v_and_b32 v29, 7, v1
    v_lshl_add_u32 v36, v29, 3, v36
    v_add_u32 v36, s55, v36
    s_lshl_b32 s50, s40, 10
    v_add_u32 v37, s50, v2
    s_waitcnt lgkmcnt(0)
    v_readfirstlane_b32 s50, v32
    s_nop 0
    s_cmp_lg_u32 s50, 7
    s_nop 1
    s_cbranch_scc1 L_NOF
    ds_read_b128 v[112:115], v34 offset:64
    ds_read_b128 v[120:123], v34 offset:80
    ds_read_b128 v[124:127], v34 offset:96
    ds_read_b128 v[128:131], v34 offset:112
    v_lshlrev_b32 v30, 3, v35
    v_add_u32 v30, s55, v30
    s_waitcnt lgkmcnt(0)
    v_max3_f32 v28, v112, v114, v120
    v_max3_f32 v28, v28, v122, v124
    v_max3_f32 v28, v28, v126, v128
    v_max_f32 v28, v28, v130
    v_sub_f32 v156, v112, v28
    v_sub_f32 v157, v114, v28
    v_sub_f32 v158, v120, v28
    v_sub_f32 v159, v122, v28
    v_sub_f32 v160, v124, v28
    v_sub_f32 v161, v126, v28
    v_sub_f32 v162, v128, v28
    v_sub_f32 v163, v130, v28
    v_exp_f32 v156, v156
    v_exp_f32 v157, v157
    v_exp_f32 v158, v158
    v_exp_f32 v159, v159
    v_exp_f32 v160, v160
    v_exp_f32 v161, v161
    v_exp_f32 v162, v162
    v_exp_f32 v163, v163
    v_mul_f32 v29, v156, v113
    v_fmac_f32 v29, v157, v115
    v_fmac_f32 v29, v158, v121
    v_fmac_f32 v29, v159, v123
    v_fmac_f32 v29, v160, v125
    v_fmac_f32 v29, v161, v127
    v_fmac_f32 v29, v162, v129
    v_fmac_f32 v29, v163, v131
    v_lshrrev_b32 v31, 1, v34
    v_lshrrev_b32 v32, 17, v0
    v_bfi_b32 v29, 1, v32, v29
    s_mov_b64 exec, 0x101
    ds_write_b128 v31, v[156:159] offset:192
    ds_write_b128 v31, v[160:163] offset:208
    s_cmp_eq_u32 s74, 1
    s_cbranch_scc1 L_PFM
    global_store_dwordx2 v30, v[28:29], s[28:29] offset:512 sc1
    s_branch L_PJM
L_PFM:
    global_store_dwordx2 v30, v[28:29], s[28:29] offset:512
L_PJM:
    s_mov_b64 exec, -1
L_NOF:
    v_mov_b32 v30, 1
    v_mov_b32 v31, 12
    v_lshrrev_b32 v32, 1, v34
    v_lshrrev_b32 v29, 16, v0
    s_mov_b32 s72, 0xffff
    v_and_b32 v20, v52, v16
    v_and_b32 v21, v52, v17
    v_and_b32 v22, v52, v18
    v_and_b32 v23, v52, v19
    v_and_b32 v24, v53, v16
    v_and_b32 v25, v53, v17
    v_and_b32 v26, v53, v18
    v_and_b32 v27, v53, v19
    s_waitcnt vmcnt(27)
    v_mfma_f32_16x16x32_bf16 v[4:7], a[0:3], v[20:23], 0
    v_and_b32 v20, v54, v16
    v_and_b32 v21, v54, v17
    v_and_b32 v22, v54, v18
    v_and_b32 v23, v54, v19
    s_waitcnt vmcnt(26)
    v_mfma_f32_16x16x32_bf16 v[4:7], a[4:7], v[24:27], v[4:7]
    v_and_b32 v24, v55, v16
    v_and_b32 v25, v55, v17
    v_and_b32 v26, v55, v18
    v_and_b32 v27, v55, v19
    s_waitcnt vmcnt(25)
    v_mfma_f32_16x16x32_bf16 v[4:7], a[8:11], v[20:23], v[4:7]
    v_and_b32 v20, v68, v16
    v_and_b32 v21, v68, v17
    v_and_b32 v22, v68, v18
    v_and_b32 v23, v68, v19
    s_waitcnt vmcnt(24)
    v_mfma_f32_16x16x32_bf16 v[4:7], a[12:15], v[24:27], v[4:7]
    s_cmp_eq_u32 s45, 0
    s_nop 5
    s_cbranch_scc1 L_SK20
    s_xor_b32 s49, s48, 114688
    buffer_load_dwordx4 v[72:75], v2, s[36:39], s49 offen nt
L_SK20:
    v_and_b32 v24, v69, v16
    v_and_b32 v25, v69, v17
    v_and_b32 v26, v69, v18
    v_and_b32 v27, v69, v19
    s_waitcnt vmcnt(24)
    v_mfma_f32_16x16x32_bf16 v[4:7], a[16:19], v[20:23], v[4:7]
    v_and_b32 v20, v70, v16
    v_and_b32 v21, v70, v17
    v_and_b32 v22, v70, v18
    v_and_b32 v23, v70, v19
    s_waitcnt vmcnt(23)
    v_mfma_f32_16x16x32_bf16 v[4:7], a[20:23], v[24:27], v[4:7]
    v_and_b32 v24, v71, v16
    v_and_b32 v25, v71, v17
    v_and_b32 v26, v71, v18
    v_and_b32 v27, v71, v19
    s_waitcnt vmcnt(22)
    v_mfma_f32_16x16x32_bf16 v[4:7], a[24:27], v[20:23], v[4:7]
    v_and_b32 v20, v84, v16
    v_and_b32 v21, v84, v17
    v_and_b32 v22, v84, v18
    v_and_b32 v23, v84, v19
    s_waitcnt vmcnt(21)
    v_mfma_f32_16x16x32_bf16 v[4:7], a[28:31], v[24:27], v[4:7]
    s_cmp_eq_u32 s45, 0
    s_nop 5
    s_cbranch_scc1 L_SK24
    s_xor_b32 s49, s48, 118784
    buffer_load_dwordx4 v[76:79], v2, s[36:39], s49 offen nt
L_SK24:
    v_and_b32 v24, v85, v16
    v_and_b32 v25, v85, v17
    v_and_b32 v26, v85, v18
    v_and_b32 v27, v85, v19
    s_waitcnt vmcnt(21)
    v_mfma_f32_16x16x32_bf16 v[4:7], a[32:35], v[20:23], v[4:7]
    v_and_b32 v20, v86, v16
    v_and_b32 v21, v86, v17
    v_and_b32 v22, v86, v18
    v_and_b32 v23, v86, v19
    s_waitcnt vmcnt(20)
    v_mfma_f32_16x16x32_bf16 v[4:7], a[36:39], v[24:27], v[4:7]
    v_and_b32 v24, v87, v16
    v_and_b32 v25, v87, v17
    v_and_b32 v26, v87, v18
    v_and_b32 v27, v87, v19
    s_waitcnt vmcnt(19)
    v_mfma_f32_16x16x32_bf16 v[4:7], a[40:43], v[20:23], v[4:7]
    v_and_b32 v20, v100, v16
    v_and_b32 v21, v100, v17
    v_and_b32 v22, v100, v18
    v_and_b32 v23, v100, v19
    s_waitcnt vmcnt(18)
    v_mfma_f32_16x16x32_bf16 v[4:7], a[44:47], v[24:27], v[4:7]
    s_cmp_eq_u32 s45, 0
    s_nop 5
    s_cbranch_scc1 L_SK28
    s_xor_b32 s49, s48, 122880
    buffer_load_dwordx4 v[80:83], v2, s[36:39], s49 offen nt
L_SK28:
    v_and_b32 v24, v101, v16
    v_and_b32 v25, v101, v17
    v_and_b32 v26, v101, v18
    v_and_b32 v27, v101, v19
    s_waitcnt vmcnt(18)
    v_mfma_f32_16x16x32_bf16 v[4:7], a[48:51], v[20:23], v[4:7]
    v_and_b32 v20, v102, v16
    v_and_b32 v21, v102, v17
    v_and_b32 v22, v102, v18
    v_and_b32 v23, v102, v19
    s_waitcnt vmcnt(17)
    v_mfma_f32_16x16x32_bf16 v[4:7], a[52:55], v[24:27], v[4:7]
    v_and_b32 v24, v103, v16
    v_and_b32 v25, v103, v17
    v_and_b32 v26, v103, v18
    v_and_b32 v27, v103, v19
    s_waitcnt vmcnt(16)
    v_mfma_f32_16x16x32_bf16 v[4:7], a[56:59], v[20:23], v[4:7]
    v_and_b32 v20, v116, v16
    v_and_b32 v21, v116, v17
    v_and_b32 v22, v116, v18
    v_and_b32 v23, v116, v19
    s_waitcnt vmcnt(15)
    v_mfma_f32_16x16x32_bf16 v[4:7], a[60:63], v[24:27], v[4:7]
    s_cmp_eq_u32 s45, 0
    s_nop 5
    s_cbranch_scc1 L_SK32
    s_xor_b32 s49, s48, 126976
    buffer_load_dwordx4 v[88:91], v2, s[36:39], s49 offen nt
    v_mov_b32 v34, 1
    v_mov_b32 v35, 28
    s_mov_b64 exec, 1
    ds_add_u32 v35, v34
    s_mov_b64 exec, -1
L_SK32:
    v_and_b32 v24, v117, v16
    v_and_b32 v25, v117, v17
    v_and_b32 v26, v117, v18
    v_and_b32 v27, v117, v19
    s_waitcnt vmcnt(15)
    v_mfma_f32_16x16x32_bf16 v[4:7], a[64:67], v[20:23], v[4:7]
    v_and_b32 v20, v118, v16
    v_and_b32 v21, v118, v17
    v_and_b32 v22, v118, v18
    v_and_b32 v23, v118, v19
    s_waitcnt vmcnt(14)
    v_mfma_f32_16x16x32_bf16 v[4:7], a[68:71], v[24:27], v[4:7]
    v_and_b32 v24, v119, v16
    v_and_b32 v25, v119, v17
    v_and_b32 v26, v119, v18
    v_and_b32 v27, v119, v19
    s_waitcnt vmcnt(13)
    v_mfma_f32_16x16x32_bf16 v[4:7], a[72:75], v[20:23], v[4:7]
    v_and_b32 v20, v132, v16
    v_and_b32 v21, v132, v17
    v_and_b32 v22, v132, v18
    v_and_b32 v23, v132, v19
    s_waitcnt vmcnt(12)
    v_mfma_f32_16x16x32_bf16 v[4:7], a[76:79], v[24:27], v[4:7]
    v_and_b32 v24, v133, v16
    v_and_b32 v25, v133, v17
    v_and_b32 v26, v133, v18
    v_and_b32 v27, v133, v19
    s_waitcnt vmcnt(11)
    v_mfma_f32_16x16x32_bf16 v[4:7], a[80:83], v[20:23], v[4:7]
    v_and_b32 v20, v134, v16
    v_and_b32 v21, v134, v17
    v_and_b32 v22, v134, v18
    v_and_b32 v23, v134, v19
    s_waitcnt vmcnt(10)
    v_mfma_f32_16x16x32_bf16 v[4:7], a[84:87], v[24:27], v[4:7]
    v_and_b32 v24, v135, v16
    v_and_b32 v25, v135, v17
    v_and_b32 v26, v135, v18
    v_and_b32 v27, v135, v19
    s_waitcnt vmcnt(9)
    v_mfma_f32_16x16x32_bf16 v[4:7], v[40:43], v[20:23], v[4:7]
    v_and_b32 v20, v148, v16
    v_and_b32 v21, v148, v17
    v_and_b32 v22, v148, v18
    v_and_b32 v23, v148, v19
    s_waitcnt vmcnt(8)
    v_mfma_f32_16x16x32_bf16 v[4:7], v[44:47], v[24:27], v[4:7]
    v_and_b32 v24, v149, v16
    v_and_b32 v25, v149, v17
    v_and_b32 v26, v149, v18
    v_and_b32 v27, v149, v19
    s_waitcnt vmcnt(7)
    v_mfma_f32_16x16x32_bf16 v[4:7], v[48:51], v[20:23], v[4:7]
    v_and_b32 v20, v150, v16
    v_and_b32 v21, v150, v17
    v_and_b32 v22, v150, v18
    v_and_b32 v23, v150, v19
    s_waitcnt vmcnt(6)
    v_mfma_f32_16x16x32_bf16 v[4:7], v[56:59], v[24:27], v[4:7]
    v_and_b32 v24, v151, v16
    v_and_b32 v25, v151, v17
    v_and_b32 v26, v151, v18
    v_and_b32 v27, v151, v19
    s_waitcnt vmcnt(5)
    v_mfma_f32_16x16x32_bf16 v[4:7], v[60:63], v[20:23], v[4:7]
    v_and_b32 v20, v164, v16
    v_and_b32 v21, v164, v17
    v_and_b32 v22, v164, v18
    v_and_b32 v23, v164, v19
    s_waitcnt vmcnt(4)
    v_mfma_f32_16x16x32_bf16 v[4:7], v[64:67], v[24:27], v[4:7]
    v_and_b32 v24, v165, v16
    v_and_b32 v25, v165, v17
    v_and_b32 v26, v165, v18
    v_and_b32 v27, v165, v19
    s_waitcnt vmcnt(3)
    v_mfma_f32_16x16x32_bf16 v[4:7], v[72:75], v[20:23], v[4:7]
    v_and_b32 v20, v166, v16
    v_and_b32 v21, v166, v17
    v_and_b32 v22, v166, v18
    v_and_b32 v23, v166, v19
    s_waitcnt vmcnt(2)
    v_mfma_f32_16x16x32_bf16 v[4:7], v[76:79], v[24:27], v[4:7]
    v_and_b32 v24, v167, v16
    v_and_b32 v25, v167, v17
    v_and_b32 v26, v167, v18
    v_and_b32 v27, v167, v19
    s_waitcnt vmcnt(1)
    v_mfma_f32_16x16x32_bf16 v[4:7], v[80:83], v[20:23], v[4:7]
    s_waitcnt vmcnt(0)
    v_mfma_f32_16x16x32_bf16 v[4:7], v[88:91], v[24:27], v[4:7]
    s_nop 7
    ds_write_b128 v37, v[4:7] offset:1024
    s_mov_b64 exec, 1
    ds_add_rtn_u32 v33, v31, v30
    s_mov_b64 exec, -1
    s_waitcnt lgkmcnt(0)
    v_readfirstlane_b32 s50, v33
    s_nop 0
    s_cmp_lg_u32 s50, 7
    s_cbranch_scc1 L_NOPUB
    ds_read_b128 v[72:75], v32 offset:192
    ds_read_b128 v[76:79], v32 offset:208
    ds_read_b128 v[40:43], v2 offset:1024
    ds_read_b128 v[44:47], v2 offset:2048
    ds_read_b128 v[48:51], v2 offset:3072
    ds_read_b128 v[52:55], v2 offset:4096
    ds_read_b128 v[56:59], v2 offset:5120
    ds_read_b128 v[60:63], v2 offset:6144
    ds_read_b128 v[64:67], v2 offset:7168
    ds_read_b128 v[68:71], v2 offset:8192
    s_waitcnt lgkmcnt(7)
    v_pk_mul_f32 v[4:5], v[40:41], v[72:73] op_sel_hi:[1,0]
    v_pk_mul_f32 v[6:7], v[42:43], v[72:73] op_sel_hi:[1,0]
    s_waitcnt lgkmcnt(6)
    v_pk_fma_f32 v[4:5], v[44:45], v[72:73], v[4:5] op_sel:[0,1,0] op_sel_hi:[1,1,1]
    v_pk_fma_f32 v[6:7], v[46:47], v[72:73], v[6:7] op_sel:[0,1,0] op_sel_hi:[1,1,1]
    s_waitcnt lgkmcnt(5)
    v_pk_fma_f32 v[4:5], v[48:49], v[74:75], v[4:5] op_sel:[0,0,0] op_sel_hi:[1,0,1]
    v_pk_fma_f32 v[6:7], v[50:51], v[74:75], v[6:7] op_sel:[0,0,0] op_sel_hi:[1,0,1]
    s_waitcnt lgkmcnt(4)
    v_pk_fma_f32 v[4:5], v[52:53], v[74:75], v[4:5] op_sel:[0,1,0] op_sel_hi:[1,1,1]
    v_pk_fma_f32 v[6:7], v[54:55], v[74:75], v[6:7] op_sel:[0,1,0] op_sel_hi:[1,1,1]
    s_waitcnt lgkmcnt(3)
    v_pk_fma_f32 v[4:5], v[56:57], v[76:77], v[4:5] op_sel:[0,0,0] op_sel_hi:[1,0,1]
    v_pk_fma_f32 v[6:7], v[58:59], v[76:77], v[6:7] op_sel:[0,0,0] op_sel_hi:[1,0,1]
    s_waitcnt lgkmcnt(2)
    v_pk_fma_f32 v[4:5], v[60:61], v[76:77], v[4:5] op_sel:[0,1,0] op_sel_hi:[1,1,1]
    v_pk_fma_f32 v[6:7], v[62:63], v[76:77], v[6:7] op_sel:[0,1,0] op_sel_hi:[1,1,1]
    s_waitcnt lgkmcnt(1)
    v_pk_fma_f32 v[4:5], v[64:65], v[78:79], v[4:5] op_sel:[0,0,0] op_sel_hi:[1,0,1]
    v_pk_fma_f32 v[6:7], v[66:67], v[78:79], v[6:7] op_sel:[0,0,0] op_sel_hi:[1,0,1]
    s_waitcnt lgkmcnt(0)
    v_pk_fma_f32 v[4:5], v[68:69], v[78:79], v[4:5] op_sel:[0,1,0] op_sel_hi:[1,1,1]
    v_pk_fma_f32 v[6:7], v[70:71], v[78:79], v[6:7] op_sel:[0,1,0] op_sel_hi:[1,1,1]
    v_cvt_pk_bf16_f32 v4, v4, v5
    v_cvt_pk_bf16_f32 v5, v6, v7
    v_bfi_b32 v4, 1, v29, v4
    s_cmp_eq_u32 s74, 1
    s_cbranch_scc1 L_PFO
    global_store_dwordx2 v36, v[4:5], s[28:29] sc1
    s_branch L_PJO
L_PFO:
    global_store_dwordx2 v36, v[4:5], s[28:29]
L_PJO:
    ds_write_b32 v31, v30 offset:12
L_NOPUB:
    s_cmp_eq_u32 s40, 2
    s_cbranch_scc1 L_HOP2
    s_cmp_lg_u32 s40, 1
    s_cbranch_scc1 L_EXIT
    s_mov_b32 s52, 32768
    v_and_b32 v28, 15, v1
    v_lshlrev_b32 v28, 4, v28
    s_nop 1
L_CBT:
    global_load_dword v29, v28, s[26:27] sc1
    s_waitcnt vmcnt(0)
    v_and_b32 v30, 0xff, v29
    v_cmp_ne_u32 vcc, 16, v30
    s_nop 0
    s_cbranch_vccz L_CBT_OK
    s_sleep 16
    s_sub_u32 s52, s52, 1
    s_cmp_lg_u32 s52, 0
    s_cbranch_scc1 L_CBT
L_CBT_OK:
    s_getreg_b32 s75, hwreg(HW_REG_XCC_ID)
    s_and_b32 s75, s75, 15
    s_mul_i32 s50, s75, s75
    s_lshl_b32 s50, s50, 8
    s_add_u32 s50, s50, s75
    s_lshl_b32 s50, s50, 8
    s_add_u32 s50, s50, 1
    s_lshl_b32 s75, s50, 4
    s_add_u32 s51, s3, 8
    v_readlane_b32 s49, v29, s3
    v_readlane_b32 s50, v29, s51
    s_cmp_eq_u32 s49, s75
    s_cselect_b32 s49, 1, 2
    s_cmp_eq_u32 s50, s75
    s_cselect_b32 s49, s49, 2
    v_mov_b32 v28, 32
    v_mov_b32 v29, s49
    ds_write_b32 v28, v29
    v_mov_b32 v31, 16
    s_mov_b32 s52, 131072
    s_nop 0
L_WW:
    ds_read_b32 v28, v31
    s_waitcnt lgkmcnt(0)
    v_readfirstlane_b32 s50, v28
    s_nop 0
    s_cmp_eq_u32 s50, 3
    s_cbranch_scc1 L_WW_OK
    s_sleep 2
    s_sub_u32 s52, s52, 1
    s_cmp_lg_u32 s52, 0
    s_cbranch_scc1 L_WW
L_WW_OK:
    v_lshrrev_b32 v28, 4, v1
    v_mul_u32_u24 v28, 288, v28
    v_and_b32 v29, 15, v1
    v_lshl_add_u32 v28, v29, 1, v28
    ds_read_u16 v120, v28 offset:18432
    ds_read_u16 v121, v28 offset:19584
    ds_read_u16 v122, v28 offset:20736
    ds_read_u16 v123, v28 offset:21888
    ds_read_u16 v124, v28 offset:18576
    ds_read_u16 v125, v28 offset:19728
    ds_read_u16 v126, v28 offset:20880
    ds_read_u16 v127, v28 offset:22032
    s_waitcnt lgkmcnt(0)
    v_lshl_or_b32 v40, v121, 16, v120
    v_lshl_or_b32 v41, v123, 16, v122
    v_lshl_or_b32 v42, v125, 16, v124
    v_lshl_or_b32 v43, v127, 16, v126
    ds_read_u16 v120, v28 offset:23040
    ds_read_u16 v121, v28 offset:24192
    ds_read_u16 v122, v28 offset:25344
    ds_read_u16 v123, v28 offset:26496
    ds_read_u16 v124, v28 offset:23184
    ds_read_u16 v125, v28 offset:24336
    ds_read_u16 v126, v28 offset:25488
    ds_read_u16 v127, v28 offset:26640
    s_waitcnt lgkmcnt(0)
    v_lshl_or_b32 v44, v121, 16, v120
    v_lshl_or_b32 v45, v123, 16, v122
    v_lshl_or_b32 v46, v125, 16, v124
    v_lshl_or_b32 v47, v127, 16, v126
    ds_read_u16 v120, v28 offset:27648
    ds_read_u16 v121, v28 offset:28800
    ds_read_u16 v122, v28 offset:29952
    ds_read_u16 v123, v28 offset:31104
    ds_read_u16 v124, v28 offset:27792
    ds_read_u16 v125, v28 offset:28944
    ds_read_u16 v126, v28 offset:30096
    ds_read_u16 v127, v28 offset:31248
    s_waitcnt lgkmcnt(0)
    v_lshl_or_b32 v48, v121, 16, v120
    v_lshl_or_b32 v49, v123, 16, v122
    v_lshl_or_b32 v50, v125, 16, v124
    v_lshl_or_b32 v51, v127, 16, v126
    ds_read_u16 v120, v28 offset:32256
    ds_read_u16 v121, v28 offset:33408
    ds_read_u16 v122, v28 offset:34560
    ds_read_u16 v123, v28 offset:35712
    ds_read_u16 v124, v28 offset:32400
    ds_read_u16 v125, v28 offset:33552
    ds_read_u16 v126, v28 offset:34704
    ds_read_u16 v127, v28 offset:35856
    s_waitcnt lgkmcnt(0)
    v_lshl_or_b32 v52, v121, 16, v120
    v_lshl_or_b32 v53, v123, 16, v122
    v_lshl_or_b32 v54, v125, 16, v124
    v_lshl_or_b32 v55, v127, 16, v126
    ds_read_u16 v120, v28 offset:18464
    ds_read_u16 v121, v28 offset:19616
    ds_read_u16 v122, v28 offset:20768
    ds_read_u16 v123, v28 offset:21920
    ds_read_u16 v124, v28 offset:18608
    ds_read_u16 v125, v28 offset:19760
    ds_read_u16 v126, v28 offset:20912
    ds_read_u16 v127, v28 offset:22064
    s_waitcnt lgkmcnt(0)
    v_lshl_or_b32 v56, v121, 16, v120
    v_lshl_or_b32 v57, v123, 16, v122
    v_lshl_or_b32 v58, v125, 16, v124
    v_lshl_or_b32 v59, v127, 16, v126
    ds_read_u16 v120, v28 offset:23072
    ds_read_u16 v121, v28 offset:24224
    ds_read_u16 v122, v28 offset:25376
    ds_read_u16 v123, v28 offset:26528
    ds_read_u16 v124, v28 offset:23216
    ds_read_u16 v125, v28 offset:24368
    ds_read_u16 v126, v28 offset:25520
    ds_read_u16 v127, v28 offset:26672
    s_waitcnt lgkmcnt(0)
    v_lshl_or_b32 v60, v121, 16, v120
    v_lshl_or_b32 v61, v123, 16, v122
    v_lshl_or_b32 v62, v125, 16, v124
    v_lshl_or_b32 v63, v127, 16, v126
    ds_read_u16 v120, v28 offset:27680
    ds_read_u16 v121, v28 offset:28832
    ds_read_u16 v122, v28 offset:29984
    ds_read_u16 v123, v28 offset:31136
    ds_read_u16 v124, v28 offset:27824
    ds_read_u16 v125, v28 offset:28976
    ds_read_u16 v126, v28 offset:30128
    ds_read_u16 v127, v28 offset:31280
    s_waitcnt lgkmcnt(0)
    v_lshl_or_b32 v64, v121, 16, v120
    v_lshl_or_b32 v65, v123, 16, v122
    v_lshl_or_b32 v66, v125, 16, v124
    v_lshl_or_b32 v67, v127, 16, v126
    ds_read_u16 v120, v28 offset:32288
    ds_read_u16 v121, v28 offset:33440
    ds_read_u16 v122, v28 offset:34592
    ds_read_u16 v123, v28 offset:35744
    ds_read_u16 v124, v28 offset:32432
    ds_read_u16 v125, v28 offset:33584
    ds_read_u16 v126, v28 offset:34736
    ds_read_u16 v127, v28 offset:35888
    s_waitcnt lgkmcnt(0)
    v_lshl_or_b32 v68, v121, 16, v120
    v_lshl_or_b32 v69, v123, 16, v122
    v_lshl_or_b32 v70, v125, 16, v124
    v_lshl_or_b32 v71, v127, 16, v126
    ds_read_u16 v120, v28 offset:18496
    ds_read_u16 v121, v28 offset:19648
    ds_read_u16 v122, v28 offset:20800
    ds_read_u16 v123, v28 offset:21952
    ds_read_u16 v124, v28 offset:18640
    ds_read_u16 v125, v28 offset:19792
    ds_read_u16 v126, v28 offset:20944
    ds_read_u16 v127, v28 offset:22096
    s_waitcnt lgkmcnt(0)
    v_lshl_or_b32 v72, v121, 16, v120
    v_lshl_or_b32 v73, v123, 16, v122
    v_lshl_or_b32 v74, v125, 16, v124
    v_lshl_or_b32 v75, v127, 16, v126
    ds_read_u16 v120, v28 offset:23104
    ds_read_u16 v121, v28 offset:24256
    ds_read_u16 v122, v28 offset:25408
    ds_read_u16 v123, v28 offset:26560
    ds_read_u16 v124, v28 offset:23248
    ds_read_u16 v125, v28 offset:24400
    ds_read_u16 v126, v28 offset:25552
    ds_read_u16 v127, v28 offset:26704
    s_waitcnt lgkmcnt(0)
    v_lshl_or_b32 v76, v121, 16, v120
    v_lshl_or_b32 v77, v123, 16, v122
    v_lshl_or_b32 v78, v125, 16, v124
    v_lshl_or_b32 v79, v127, 16, v126
    ds_read_u16 v120, v28 offset:27712
    ds_read_u16 v121, v28 offset:28864
    ds_read_u16 v122, v28 offset:30016
    ds_read_u16 v123, v28 offset:31168
    ds_read_u16 v124, v28 offset:27856
    ds_read_u16 v125, v28 offset:29008
    ds_read_u16 v126, v28 offset:30160
    ds_read_u16 v127, v28 offset:31312
    s_waitcnt lgkmcnt(0)
    v_lshl_or_b32 v80, v121, 16, v120
    v_lshl_or_b32 v81, v123, 16, v122
    v_lshl_or_b32 v82, v125, 16, v124
    v_lshl_or_b32 v83, v127, 16, v126
    ds_read_u16 v120, v28 offset:32320
    ds_read_u16 v121, v28 offset:33472
    ds_read_u16 v122, v28 offset:34624
    ds_read_u16 v123, v28 offset:35776
    ds_read_u16 v124, v28 offset:32464
    ds_read_u16 v125, v28 offset:33616
    ds_read_u16 v126, v28 offset:34768
    ds_read_u16 v127, v28 offset:35920
    s_waitcnt lgkmcnt(0)
    v_lshl_or_b32 v84, v121, 16, v120
    v_lshl_or_b32 v85, v123, 16, v122
    v_lshl_or_b32 v86, v125, 16, v124
    v_lshl_or_b32 v87, v127, 16, v126
    ds_read_u16 v120, v28 offset:18528
    ds_read_u16 v121, v28 offset:19680
    ds_read_u16 v122, v28 offset:20832
    ds_read_u16 v123, v28 offset:21984
    ds_read_u16 v124, v28 offset:18672
    ds_read_u16 v125, v28 offset:19824
    ds_read_u16 v126, v28 offset:20976
    ds_read_u16 v127, v28 offset:22128
    s_waitcnt lgkmcnt(0)
    v_lshl_or_b32 v88, v121, 16, v120
    v_lshl_or_b32 v89, v123, 16, v122
    v_lshl_or_b32 v90, v125, 16, v124
    v_lshl_or_b32 v91, v127, 16, v126
    ds_read_u16 v120, v28 offset:23136
    ds_read_u16 v121, v28 offset:24288
    ds_read_u16 v122, v28 offset:25440
    ds_read_u16 v123, v28 offset:26592
    ds_read_u16 v124, v28 offset:23280
    ds_read_u16 v125, v28 offset:24432
    ds_read_u16 v126, v28 offset:25584
    ds_read_u16 v127, v28 offset:26736
    s_waitcnt lgkmcnt(0)
    v_lshl_or_b32 v92, v121, 16, v120
    v_lshl_or_b32 v93, v123, 16, v122
    v_lshl_or_b32 v94, v125, 16, v124
    v_lshl_or_b32 v95, v127, 16, v126
    ds_read_u16 v120, v28 offset:27744
    ds_read_u16 v121, v28 offset:28896
    ds_read_u16 v122, v28 offset:30048
    ds_read_u16 v123, v28 offset:31200
    ds_read_u16 v124, v28 offset:27888
    ds_read_u16 v125, v28 offset:29040
    ds_read_u16 v126, v28 offset:30192
    ds_read_u16 v127, v28 offset:31344
    s_waitcnt lgkmcnt(0)
    v_lshl_or_b32 v96, v121, 16, v120
    v_lshl_or_b32 v97, v123, 16, v122
    v_lshl_or_b32 v98, v125, 16, v124
    v_lshl_or_b32 v99, v127, 16, v126
    ds_read_u16 v120, v28 offset:32352
    ds_read_u16 v121, v28 offset:33504
    ds_read_u16 v122, v28 offset:34656
    ds_read_u16 v123, v28 offset:35808
    ds_read_u16 v124, v28 offset:32496
    ds_read_u16 v125, v28 offset:33648
    ds_read_u16 v126, v28 offset:34800
    ds_read_u16 v127, v28 offset:35952
    s_waitcnt lgkmcnt(0)
    v_lshl_or_b32 v100, v121, 16, v120
    v_lshl_or_b32 v101, v123, 16, v122
    v_lshl_or_b32 v102, v125, 16, v124
    v_lshl_or_b32 v103, v127, 16, v126
    ds_read_u16 v120, v28 offset:18560
    ds_read_u16 v121, v28 offset:19712
    ds_read_u16 v122, v28 offset:20864
    ds_read_u16 v123, v28 offset:22016
    ds_read_u16 v124, v28 offset:18704
    ds_read_u16 v125, v28 offset:19856
    ds_read_u16 v126, v28 offset:21008
    ds_read_u16 v127, v28 offset:22160
    s_waitcnt lgkmcnt(0)
    v_lshl_or_b32 v104, v121, 16, v120
    v_lshl_or_b32 v105, v123, 16, v122
    v_lshl_or_b32 v106, v125, 16, v124
    v_lshl_or_b32 v107, v127, 16, v126
    ds_read_u16 v120, v28 offset:23168
    ds_read_u16 v121, v28 offset:24320
    ds_read_u16 v122, v28 offset:25472
    ds_read_u16 v123, v28 offset:26624
    ds_read_u16 v124, v28 offset:23312
    ds_read_u16 v125, v28 offset:24464
    ds_read_u16 v126, v28 offset:25616
    ds_read_u16 v127, v28 offset:26768
    s_waitcnt lgkmcnt(0)
    v_lshl_or_b32 v108, v121, 16, v120
    v_lshl_or_b32 v109, v123, 16, v122
    v_lshl_or_b32 v110, v125, 16, v124
    v_lshl_or_b32 v111, v127, 16, v126
    ds_read_u16 v120, v28 offset:27776
    ds_read_u16 v121, v28 offset:28928
    ds_read_u16 v122, v28 offset:30080
    ds_read_u16 v123, v28 offset:31232
    ds_read_u16 v124, v28 offset:27920
    ds_read_u16 v125, v28 offset:29072
    ds_read_u16 v126, v28 offset:30224
    ds_read_u16 v127, v28 offset:31376
    s_waitcnt lgkmcnt(0)
    v_lshl_or_b32 v112, v121, 16, v120
    v_lshl_or_b32 v113, v123, 16, v122
    v_lshl_or_b32 v114, v125, 16, v124
    v_lshl_or_b32 v115, v127, 16, v126
    ds_read_u16 v120, v28 offset:32384
    ds_read_u16 v121, v28 offset:33536
    ds_read_u16 v122, v28 offset:34688
    ds_read_u16 v123, v28 offset:35840
    ds_read_u16 v124, v28 offset:32528
    ds_read_u16 v125, v28 offset:33680
    ds_read_u16 v126, v28 offset:34832
    ds_read_u16 v127, v28 offset:35984
    s_waitcnt lgkmcnt(0)
    v_lshl_or_b32 v116, v121, 16, v120
    v_lshl_or_b32 v117, v123, 16, v122
    v_lshl_or_b32 v118, v125, 16, v124
    v_lshl_or_b32 v119, v127, 16, v126
    s_lshr_b32 s49, s47, 1
    s_mul_i32 s49, s49, 10240
    s_add_u32 s49, s49, 262144
    s_and_b32 s50, s47, 1
    s_lshl_b32 s51, s50, 8
    s_add_u32 s51, s51, s49
    v_and_b32 v28, 15, v1
    v_mul_u32_u24 v160, 640, v28
    v_lshrrev_b32 v28, 4, v1
    v_lshl_add_u32 v160, v28, 4, v160
    v_add_u32 v160, s51, v160
    s_lshl_b32 s51, s50, 3
    s_add_u32 s51, s51, s49
    s_add_u32 s51, s51, 512
    v_mul_u32_u24 v161, 2560, v28
    v_add_u32 v161, s51, v161
    v_lshrrev_b32 v162, 5, v1
    v_mul_u32_u24 v162, 384, v162
    v_and_b32 v28, 31, v1
    v_lshl_add_u32 v162, v28, 2, v162
    s_add_u32 s49, s70, 458752
    v_add_u32 v162, s49, v162
    v_lshrrev_b32 v165, 18, v0
    v_lshrrev_b32 v166, 19, v0
    v_lshrrev_b32 v167, 20, v0
    v_mov_b32 v163, 1
    v_mov_b32 v164, 20
    v_mov_b32 v31, 28
    s_mov_b32 s52, 131072
    s_nop 0
L_OW:
    ds_read_b32 v28, v31
    s_waitcnt lgkmcnt(0)
    v_readfirstlane_b32 s50, v28
    s_nop 0
    s_cmp_eq_u32 s50, 4
    s_cbranch_scc1 L_OW_OK
    s_sleep 1
    s_sub_u32 s52, s52, 1
    s_cmp_lg_u32 s52, 0
    s_cbranch_scc1 L_OW
L_OW_OK:
    v_lshlrev_b32 v29, 20, v0
    s_mov_b32 s52, 32768
    s_nop 0
L_HM:
    global_load_dwordx2 v[152:153], v161, s[28:29] offset:0 sc1
    global_load_dwordx2 v[154:155], v161, s[28:29] offset:640 sc1
    global_load_dwordx2 v[156:157], v161, s[28:29] offset:1280 sc1
    global_load_dwordx2 v[158:159], v161, s[28:29] offset:1920 sc1
    s_waitcnt vmcnt(0)
    v_alignbit_b32 v28, v153, v153, 1
    v_alignbit_b32 v28, v155, v28, 1
    v_alignbit_b32 v28, v157, v28, 1
    v_alignbit_b32 v28, v159, v28, 1
    v_xor_b32 v28, v28, v29
    v_cmp_le_u32 vcc, 0x10000000, v28
    s_nop 0
    s_cbranch_vccz L_HM_OK
    s_mov_b64 exec, vcc
    s_sub_u32 s52, s52, 1
    s_cmp_lg_u32 s52, 0
    s_cbranch_scc1 L_HM
L_HM_OK:
    s_mov_b64 exec, -1
    v_and_b32 v153, -2, v153
    v_and_b32 v155, -2, v155
    v_and_b32 v157, -2, v157
    v_and_b32 v159, -2, v159
    v_max3_f32 v28, v152, v154, v156
    v_max_f32 v28, v28, v158
    v_mov_b32 v29, v28
    s_nop 1
    v_permlane16_swap_b32 v29, v28
    v_max_f32 v28, v29, v28
    v_sub_f32 v152, v152, v28
    v_sub_f32 v154, v154, v28
    v_sub_f32 v156, v156, v28
    v_sub_f32 v158, v158, v28
    v_exp_f32 v152, v152
    v_exp_f32 v154, v154
    v_exp_f32 v156, v156
    v_exp_f32 v158, v158
    v_mul_f32 v30, v152, v153
    v_fmac_f32 v30, v154, v155
    v_fmac_f32 v30, v156, v157
    v_fmac_f32 v30, v158, v159
    v_mov_b32 v29, v30
    s_nop 1
    v_permlane16_swap_b32 v29, v30
    v_add_f32 v30, v29, v30
    v_rcp_f32 v30, v30
    s_nop 0
    v_mul_f32 v24, v152, v30
    v_mul_f32 v25, v154, v30
    v_mul_f32 v26, v156, v30
    v_mul_f32 v27, v158, v30
    v_mov_b32 v31, 24
    s_mov_b32 s52, 131072
    s_nop 0
L_PW:
    ds_read_b32 v28, v31
    s_waitcnt lgkmcnt(0)
    v_readfirstlane_b32 s50, v28
    s_nop 0
    s_cmp_eq_u32 s50, 1
    s_cbranch_scc1 L_PW_OK
    s_sleep 1
    s_sub_u32 s52, s52, 1
    s_cmp_lg_u32 s52, 0
    s_cbranch_scc1 L_PW
L_PW_OK:
    v_lshlrev_b32 v29, 24, v0
    s_mov_b32 s52, 32768
    s_nop 0
L_H1:
    global_load_dwordx4 v[136:139], v160, s[28:29] offset:0 sc1
    global_load_dwordx4 v[140:143], v160, s[28:29] offset:64 sc1
    global_load_dwordx4 v[144:147], v160, s[28:29] offset:128 sc1
    global_load_dwordx4 v[148:151], v160, s[28:29] offset:192 sc1
    s_waitcnt vmcnt(0)
    v_alignbit_b32 v28, v136, v136, 1
    v_alignbit_b32 v28, v138, v28, 1
    v_alignbit_b32 v28, v140, v28, 1
    v_alignbit_b32 v28, v142, v28, 1
    v_alignbit_b32 v28, v144, v28, 1
    v_alignbit_b32 v28, v146, v28, 1
    v_alignbit_b32 v28, v148, v28, 1
    v_alignbit_b32 v28, v150, v28, 1
    v_xor_b32 v28, v28, v29
    v_cmp_le_u32 vcc, 0x01000000, v28
    s_nop 0
    s_cbranch_vccz L_H1_OK
    s_mov_b64 exec, vcc
    s_sub_u32 s52, s52, 1
    s_cmp_lg_u32 s52, 0
    s_cbranch_scc1 L_H1
L_H1_OK:
    s_mov_b64 exec, -1
    v_and_b32 v136, -2, v136
    v_and_b32 v138, -2, v138
    v_and_b32 v140, -2, v140
    v_and_b32 v142, -2, v142
    v_and_b32 v144, -2, v144
    v_and_b32 v146, -2, v146
    v_and_b32 v148, -2, v148
    v_and_b32 v150, -2, v150
    v_mfma_f32_16x16x32_bf16 v[20:23], v[136:139], v[104:107], 0
    v_mfma_f32_16x16x32_bf16 v[4:7], v[136:139], v[40:43], 0
    v_mfma_f32_16x16x32_bf16 v[20:23], v[140:143], v[108:111], v[20:23]
    v_mfma_f32_16x16x32_bf16 v[4:7], v[140:143], v[44:47], v[4:7]
    v_mfma_f32_16x16x32_bf16 v[20:23], v[144:147], v[112:115], v[20:23]
    v_mfma_f32_16x16x32_bf16 v[4:7], v[144:147], v[48:51], v[4:7]
    v_mfma_f32_16x16x32_bf16 v[20:23], v[148:151], v[116:119], v[20:23]
    v_mfma_f32_16x16x32_bf16 v[4:7], v[148:151], v[52:55], v[4:7]
    v_mfma_f32_16x16x32_bf16 v[8:11], v[136:139], v[56:59], 0
    s_nop 5
    v_mul_f32 v32, v24, v20
    v_fmac_f32 v32, v25, v21
    v_mfma_f32_16x16x32_bf16 v[8:11], v[140:143], v[60:63], v[8:11]
    v_fmac_f32 v32, v26, v22
    v_fmac_f32 v32, v27, v23
    v_mov_b32 v33, v32
    v_mfma_f32_16x16x32_bf16 v[8:11], v[144:147], v[64:67], v[8:11]
    s_nop 0
    v_permlane16_swap_b32 v33, v32
    v_add_f32 v32, v33, v32
    v_bfi_b32 v32, 1, v167, v32
    v_mfma_f32_16x16x32_bf16 v[8:11], v[148:151], v[68:71], v[8:11]
    global_store_dword v162, v32, s[28:29] offset:256 sc1
    v_mfma_f32_16x16x32_bf16 v[12:15], v[136:139], v[72:75], 0
    v_mul_f32 v28, v24, v4
    v_fmac_f32 v28, v25, v5
    v_mfma_f32_16x16x32_bf16 v[16:19], v[136:139], v[88:91], 0
    v_fmac_f32 v28, v26, v6
    v_fmac_f32 v28, v27, v7
    v_mfma_f32_16x16x32_bf16 v[12:15], v[140:143], v[76:79], v[12:15]
    v_mul_f32 v29, v24, v8
    v_mfma_f32_16x16x32_bf16 v[16:19], v[140:143], v[92:95], v[16:19]
    v_fmac_f32 v29, v25, v9
    v_fmac_f32 v29, v26, v10
    v_mfma_f32_16x16x32_bf16 v[12:15], v[144:147], v[80:83], v[12:15]
    v_fmac_f32 v29, v27, v11
    v_mfma_f32_16x16x32_bf16 v[16:19], v[144:147], v[96:99], v[16:19]
    s_nop 0
    v_permlane16_swap_b32 v28, v29
    v_add_f32 v29, v28, v29
    v_mfma_f32_16x16x32_bf16 v[12:15], v[148:151], v[84:87], v[12:15]
    v_bfi_b32 v29, 1, v165, v29
    global_store_dword v162, v29, s[28:29] offset:0 sc1
    v_mfma_f32_16x16x32_bf16 v[16:19], v[148:151], v[100:103], v[16:19]
    s_nop 4
    v_mul_f32 v30, v24, v12
    v_fmac_f32 v30, v25, v13
    v_fmac_f32 v30, v26, v14
    v_fmac_f32 v30, v27, v15
    v_mul_f32 v31, v24, v16
    v_fmac_f32 v31, v25, v17
    v_fmac_f32 v31, v26, v18
    v_fmac_f32 v31, v27, v19
    s_nop 1
    v_permlane16_swap_b32 v30, v31
    v_add_f32 v31, v30, v31
    v_bfi_b32 v31, 1, v166, v31
    global_store_dword v162, v31, s[28:29] offset:128 sc1
    ds_write_b32 v164, v163
    s_mov_b64 exec, -1
    s_branch L_EXIT
L_HOP2:
    s_cmp_ge_u32 s2, 144
    s_cbranch_scc1 L_EXIT
    s_lshr_b32 s49, s2, 3
    s_min_u32 s49, s49, 17
    s_and_b32 s50, s2, 7
    s_cmp_ge_u32 s49, 9
    s_cselect_b32 s51, 96, 0
    s_cselect_b32 s53, 63, 0
    s_add_u32 s53, s53, s49
    s_mul_i32 s52, s50, 9
    s_add_u32 s53, s53, s52
    s_lshl_b32 s49, s49, 5
    s_add_u32 s51, s51, s49
    s_mul_i32 s50, s50, 24576
    s_add_u32 s51, s51, s50
    s_add_u32 s51, s51, 458752
    v_lshrrev_b32 v160, 3, v1
    v_mul_u32_u24 v160, 3072, v160
    v_and_b32 v161, 7, v1
    v_lshl_add_u32 v160, v161, 2, v160
    v_add_u32 v160, s51, v160
    v_add_u32 v28, 229376, v160
    v_mov_b32 v126, v28
    v_lshlrev_b32 v161, 1, v161
    s_lshl_b32 s49, s53, 4
    v_add_u32 v161, s49, v161
    global_load_ushort v39, v161, s[4:5]
    v_mov_b32 v29, 0
    global_load_ushort v124, v29, s[22:23]
    v_mov_b32 v31, 8
    s_mov_b32 s52, 131072
    s_nop 0
L_YW:
    ds_read_b32 v28, v31
    s_waitcnt lgkmcnt(0)
    v_readfirstlane_b32 s50, v28
    s_nop 0
    s_cmp_eq_u32 s50, 8
    s_cbranch_scc1 L_YW_OK
    s_sleep 4
    s_sub_u32 s52, s52, 1
    s_cmp_lg_u32 s52, 0
    s_cbranch_scc1 L_YW
L_YW_OK:
    v_lshlrev_b32 v29, 4, v0
    s_mov_b32 s52, 32768
    s_nop 0
L_HY:
    global_load_dword v120, v126, s[28:29] offset:0 sc1
    global_load_dword v121, v126, s[28:29] offset:768 sc1
    global_load_dword v122, v126, s[28:29] offset:1536 sc1
    global_load_dword v123, v126, s[28:29] offset:2304 sc1
    s_waitcnt vmcnt(0)
    v_alignbit_b32 v28, v120, v120, 1
    v_alignbit_b32 v28, v121, v28, 1
    v_alignbit_b32 v28, v122, v28, 1
    v_alignbit_b32 v28, v123, v28, 1
    v_xor_b32 v28, v28, v29
    v_cmp_le_u32 vcc, 0x10000000, v28
    s_nop 0
    s_cbranch_vccz L_HY_OK
    s_mov_b64 exec, vcc
    s_sleep 32
    s_sub_u32 s52, s52, 1
    s_cmp_lg_u32 s52, 0
    s_cbranch_scc1 L_HY
L_HY_OK:
    s_mov_b64 exec, -1
    v_and_b32 v120, -2, v120
    v_and_b32 v121, -2, v121
    v_and_b32 v122, -2, v122
    v_and_b32 v123, -2, v123
    s_waitcnt vmcnt(0)
    v_add_f32 v120, v120, v121
    v_add_f32 v122, v122, v123
    v_add_f32 v120, v120, v122
    s_nop 1
    v_add_f32_dpp v120, v120, v120 row_ror:8 row_mask:0xf bank_mask:0xf
    v_mov_b32 v125, v120
    s_nop 1
    v_permlane16_swap_b32 v125, v120
    v_add_f32 v120, v125, v120
    v_mov_b32 v125, v120
    s_nop 1
    v_permlane32_swap_b32 v125, v120
    v_add_f32 v120, v125, v120
    v_cvt_pk_bf16_f32 v120, v120, v120
    v_lshlrev_b32 v120, 16, v120
    v_lshlrev_b32 v124, 16, v124
    v_add_f32 v120, v120, v124
    v_cvt_pk_bf16_f32 v120, v120, v120
    v_lshlrev_b32 v120, 16, v120
    v_mul_f32 v121, 0xbfb8aa3b, v120
    v_exp_f32 v121, v121
    s_nop 0
    v_add_f32 v121, 1.0, v121
    v_rcp_f32 v121, v121
    s_nop 0
    v_mul_f32 v38, v120, v121
    v_cvt_pk_bf16_f32 v38, v38, v38
    v_lshlrev_b32 v38, 16, v38
    v_lshlrev_b32 v39, 16, v39
    v_mov_b32 v31, 20
    s_mov_b32 s52, 131072
    s_nop 0
L_OW2:
    ds_read_b32 v28, v31
    s_waitcnt lgkmcnt(0)
    v_readfirstlane_b32 s50, v28
    s_nop 0
    s_cmp_eq_u32 s50, 1
    s_cbranch_scc1 L_OW2_OK
    s_sleep 1
    s_sub_u32 s52, s52, 1
    s_cmp_lg_u32 s52, 0
    s_cbranch_scc1 L_OW2
L_OW2_OK:
    v_lshlrev_b32 v29, 16, v0
    s_mov_b32 s52, 32768
    s_nop 0
L_H2:
    global_load_dword v112, v160, s[28:29] offset:0 sc1
    global_load_dword v113, v160, s[28:29] offset:768 sc1
    global_load_dword v114, v160, s[28:29] offset:1536 sc1
    global_load_dword v115, v160, s[28:29] offset:2304 sc1
    s_waitcnt vmcnt(0)
    v_alignbit_b32 v28, v112, v112, 1
    v_alignbit_b32 v28, v113, v28, 1
    v_alignbit_b32 v28, v114, v28, 1
    v_alignbit_b32 v28, v115, v28, 1
    v_xor_b32 v28, v28, v29
    v_cmp_le_u32 vcc, 0x10000000, v28
    s_nop 0
    s_cbranch_vccz L_H2_OK
    s_mov_b64 exec, vcc
    s_sub_u32 s52, s52, 1
    s_cmp_lg_u32 s52, 0
    s_cbranch_scc1 L_H2
L_H2_OK:
    s_mov_b64 exec, -1
    v_and_b32 v112, -2, v112
    v_and_b32 v113, -2, v113
    v_and_b32 v114, -2, v114
    v_and_b32 v115, -2, v115
    v_add_f32 v112, v112, v113
    v_add_f32 v114, v114, v115
    v_add_f32 v112, v112, v114
    s_nop 1
    v_add_f32_dpp v112, v112, v112 row_ror:8 row_mask:0xf bank_mask:0xf
    v_mov_b32 v28, v112
    s_nop 1
    v_permlane16_swap_b32 v28, v112
    v_add_f32 v112, v28, v112
    v_mov_b32 v28, v112
    s_nop 1
    v_permlane32_swap_b32 v28, v112
    v_add_f32 v112, v28, v112
    v_cvt_pk_bf16_f32 v112, v112, v112
    v_lshlrev_b32 v112, 16, v112
    v_mul_f32 v112, v112, v38
    v_cvt_pk_bf16_f32 v112, v112, v112
    v_lshlrev_b32 v112, 16, v112
    v_add_f32 v112, v112, v39
    v_cvt_pk_bf16_f32 v112, v112, v112
    s_mov_b64 exec, 0xff
    global_store_short v161, v112, s[24:25]
    s_mov_b64 exec, -1
L_EXIT:
L_END:
    s_endpgm
L_SERVICE:
    s_cmp_lg_u32 s40, 0
    s_cbranch_scc1 L_Y_PRE
    s_setprio 3
    v_lshrrev_b32 v28, 5, v1
    v_mul_u32_u24 v28, 1152, v28
    v_and_b32 v3, 31, v1
    v_lshl_add_u32 v3, v3, 2, v28
    global_load_dword v40, v3, s[4:5] offset:0
    global_load_dword v41, v3, s[4:5] offset:128
    global_load_dword v42, v3, s[4:5] offset:256
    global_load_dword v43, v3, s[4:5] offset:384
    global_load_dword v44, v3, s[4:5] offset:512
    global_load_dword v45, v3, s[4:5] offset:640
    global_load_dword v46, v3, s[4:5] offset:768
    global_load_dword v47, v3, s[4:5] offset:896
    global_load_dword v48, v3, s[4:5] offset:1024
    s_mov_b32 s60, s10
    s_mov_b32 s61, s11
    s_mov_b32 s62, 4718592
    s_mov_b32 s63, 0x20000
    v_lshrrev_b32 v32, 3, v1
    v_lshlrev_b32 v32, 13, v32
    v_and_b32 v29, 7, v1
    v_lshl_add_u32 v32, v29, 4, v32
    s_lshr_b32 s49, s44, 2
    s_mul_i32 s49, s49, 1179648
    s_lshl_b32 s50, s41, 9
    s_add_u32 s49, s49, s50
    s_and_b32 s50, s44, 3
    s_lshl_b32 s50, s50, 7
    s_add_u32 s49, s49, s50
    buffer_load_dwordx4 v[96:99], v32, s[60:63], s49 offen nt
    s_add_u32 s49, s49, 65536
    buffer_load_dwordx4 v[100:103], v32, s[60:63], s49 offen nt
    s_add_u32 s49, s49, 65536
    buffer_load_dwordx4 v[104:107], v32, s[60:63], s49 offen nt
    s_add_u32 s49, s49, 65536
    buffer_load_dwordx4 v[108:111], v32, s[60:63], s49 offen nt
    s_add_u32 s49, s49, 65536
    buffer_load_dwordx4 v[112:115], v32, s[60:63], s49 offen nt
    s_add_u32 s49, s49, 65536
    buffer_load_dwordx4 v[116:119], v32, s[60:63], s49 offen nt
    s_add_u32 s49, s49, 65536
    buffer_load_dwordx4 v[120:123], v32, s[60:63], s49 offen nt
    s_add_u32 s49, s49, 65536
    buffer_load_dwordx4 v[124:127], v32, s[60:63], s49 offen nt
    s_add_u32 s49, s49, 65536
    buffer_load_dwordx4 v[128:131], v32, s[60:63], s49 offen nt
    s_add_u32 s49, s49, 65536
    buffer_load_dwordx4 v[132:135], v32, s[60:63], s49 offen nt
    s_add_u32 s49, s49, 65536
    buffer_load_dwordx4 v[136:139], v32, s[60:63], s49 offen nt
    s_add_u32 s49, s49, 65536
    buffer_load_dwordx4 v[140:143], v32, s[60:63], s49 offen nt
    s_add_u32 s49, s49, 65536
    buffer_load_dwordx4 v[144:147], v32, s[60:63], s49 offen nt
    s_add_u32 s49, s49, 65536
    buffer_load_dwordx4 v[148:151], v32, s[60:63], s49 offen nt
    s_add_u32 s49, s49, 65536
    buffer_load_dwordx4 v[152:155], v32, s[60:63], s49 offen nt
    s_add_u32 s49, s49, 65536
    buffer_load_dwordx4 v[156:159], v32, s[60:63], s49 offen nt
    s_add_u32 s49, s49, 65536
    buffer_load_dwordx4 v[160:163], v32, s[60:63], s49 offen nt
    s_add_u32 s49, s49, 65536
    buffer_load_dwordx4 v[164:167], v32, s[60:63], s49 offen nt
L_W0B:
    s_mov_b32 s47, s68
    s_mov_b32 s46, s69
    s_lshl_b32 s55, s41, 4
    s_add_u32 s55, s55, s44
    s_mul_i32 s55, s55, 640
    s_add_u32 s55, s55, 262144
    s_lshl_b32 s70, s46, 5
    s_add_u32 s70, s70, s47
    s_mul_i32 s70, s70, 768
    s_lshr_b32 s31, s2, 3
    s_and_b32 s3, s2, 7
    s_lshl_b32 s30, s3, 5
    s_add_u32 s30, s30, s31
    s_mul_i32 s30, s30, 768
    v_and_b32 v19, 1, v1
    v_lshlrev_b32 v19, 4, v19
    v_mov_b32 v18, 0xffff
    v_lshlrev_b32 v19, v19, v18
    v_bfe_u32 v8, v1, 1, 2
    v_cmp_eq_u32 vcc, 0, v8
    s_nop 1
    v_cndmask_b32 v16, 0, v19, vcc
    v_cmp_eq_u32 vcc, 1, v8
    s_nop 1
    v_cndmask_b32 v17, 0, v19, vcc
    v_cmp_eq_u32 vcc, 2, v8
    s_nop 1
    v_cndmask_b32 v18, 0, v19, vcc
    v_cmp_eq_u32 vcc, 3, v8
    s_nop 1
    v_cndmask_b32 v19, 0, v19, vcc
    s_mov_b32 s54, 0x3fb8aa3b
    s_barrier
    s_add_u32 s58, s55, 528
    s_load_dword s73, s[28:29], s58 glc
    s_mov_b32 s53, 1
    s_mov_b32 s51, 9216
    s_waitcnt vmcnt(18)
    s_branch L_LN
L_Y_PRE:
    s_setprio 2
    v_lshrrev_b32 v28, 5, v1
    v_mul_u32_u24 v28, 1152, v28
    v_and_b32 v3, 31, v1
    v_lshl_add_u32 v3, v3, 2, v28
    global_load_dword v40, v3, s[4:5] offset:0
    global_load_dword v41, v3, s[4:5] offset:128
    global_load_dword v42, v3, s[4:5] offset:256
    global_load_dword v43, v3, s[4:5] offset:384
    global_load_dword v44, v3, s[4:5] offset:512
    global_load_dword v45, v3, s[4:5] offset:640
    global_load_dword v46, v3, s[4:5] offset:768
    global_load_dword v47, v3, s[4:5] offset:896
    global_load_dword v48, v3, s[4:5] offset:1024
    s_mov_b32 s47, s68
    s_mov_b32 s46, s69
    s_lshl_b32 s55, s41, 4
    s_add_u32 s55, s55, s44
    s_mul_i32 s55, s55, 640
    s_add_u32 s55, s55, 262144
    s_lshl_b32 s70, s46, 5
    s_add_u32 s70, s70, s47
    s_mul_i32 s70, s70, 768
    s_lshr_b32 s31, s2, 3
    s_and_b32 s3, s2, 7
    s_lshl_b32 s30, s3, 5
    s_add_u32 s30, s30, s31
    s_mul_i32 s30, s30, 768
    v_and_b32 v19, 1, v1
    v_lshlrev_b32 v19, 4, v19
    v_mov_b32 v18, 0xffff
    v_lshlrev_b32 v19, v19, v18
    v_bfe_u32 v8, v1, 1, 2
    v_cmp_eq_u32 vcc, 0, v8
    s_nop 1
    v_cndmask_b32 v16, 0, v19, vcc
    v_cmp_eq_u32 vcc, 1, v8
    s_nop 1
    v_cndmask_b32 v17, 0, v19, vcc
    v_cmp_eq_u32 vcc, 2, v8
    s_nop 1
    v_cndmask_b32 v18, 0, v19, vcc
    v_cmp_eq_u32 vcc, 3, v8
    s_nop 1
    v_cndmask_b32 v19, 0, v19, vcc
    s_mov_b32 s54, 0x3fb8aa3b
    s_barrier
    v_and_b32 v28, 7, v1
    v_mul_u32_u24 v28, 36, v28
    s_mul_i32 s49, s31, 288
    v_add_u32 v28, s49, v28
    global_load_dwordx4 v[70:73], v28, s[16:17]
    global_load_dwordx4 v[74:77], v28, s[16:17] offset:16
    global_load_dword v78, v28, s[16:17] offset:32
    global_load_dwordx4 v[80:83], v28, s[18:19]
    global_load_dwordx4 v[84:87], v28, s[18:19] offset:16
    global_load_dword v88, v28, s[18:19] offset:32
    global_load_dwordx4 v[90:93], v28, s[20:21]
    global_load_dwordx4 v[94:97], v28, s[20:21] offset:16
    global_load_dword v98, v28, s[20:21] offset:32
    s_cmp_lg_u32 s40, 5
    s_cbranch_scc1 L_NOSN
    s_waitcnt vmcnt(9)
    s_lshr_b32 s49, s47, 1
    s_mul_i32 s49, s49, 10240
    s_add_u32 s49, s49, 262144
    s_and_b32 s50, s47, 1
    s_lshl_b32 s51, s50, 8
    s_add_u32 s51, s51, s49
    v_and_b32 v30, 15, v1
    v_mul_u32_u24 v28, 640, v30
    v_lshrrev_b32 v30, 4, v1
    v_lshl_add_u32 v28, v30, 4, v28
    v_add_u32 v28, s51, v28
    s_lshl_b32 s51, s50, 3
    s_add_u32 s51, s51, s49
    s_add_u32 s51, s51, 512
    v_mul_u32_u24 v29, 2560, v30
    v_add_u32 v29, s51, v29
    global_load_dwordx4 v[100:103], v28, s[28:29] offset:0 sc1
    global_load_dwordx4 v[104:107], v28, s[28:29] offset:64 sc1
    global_load_dwordx4 v[108:111], v28, s[28:29] offset:128 sc1
    global_load_dwordx4 v[112:115], v28, s[28:29] offset:192 sc1
    global_load_dwordx2 v[116:117], v29, s[28:29] offset:0 sc1
    global_load_dwordx2 v[118:119], v29, s[28:29] offset:640 sc1
    global_load_dwordx2 v[120:121], v29, s[28:29] offset:1280 sc1
    global_load_dwordx2 v[122:123], v29, s[28:29] offset:1920 sc1
    s_cmp_ge_u32 s2, 144
    s_cbranch_scc1 L_NOIN2
    s_lshr_b32 s49, s2, 3
    s_min_u32 s49, s49, 17
    s_and_b32 s50, s2, 7
    s_cmp_ge_u32 s49, 9
    s_cselect_b32 s51, 96, 0
    s_cselect_b32 s53, 63, 0
    s_add_u32 s53, s53, s49
    s_mul_i32 s52, s50, 9
    s_add_u32 s53, s53, s52
    s_lshl_b32 s49, s49, 5
    s_add_u32 s51, s51, s49
    s_mul_i32 s50, s50, 24576
    s_add_u32 s51, s51, s50
    s_add_u32 s51, s51, 458752
    v_lshrrev_b32 v28, 3, v1
    v_mul_u32_u24 v28, 3072, v28
    v_and_b32 v30, 7, v1
    v_lshl_add_u32 v28, v30, 2, v28
    v_add_u32 v28, s51, v28
    global_load_dword v124, v28, s[28:29] offset:0 sc1
    global_load_dword v125, v28, s[28:29] offset:768 sc1
    global_load_dword v126, v28, s[28:29] offset:1536 sc1
    global_load_dword v127, v28, s[28:29] offset:2304 sc1
    v_add_u32 v28, 229376, v28
    global_load_dword v136, v28, s[28:29] offset:0 sc1
    global_load_dword v137, v28, s[28:29] offset:768 sc1
    global_load_dword v138, v28, s[28:29] offset:1536 sc1
    global_load_dword v139, v28, s[28:29] offset:2304 sc1
L_NOIN2:
    v_and_b32 v30, 7, v1
    v_min_u32 v30, 5, v30
    v_add_u32 v30, 0, v30
    v_cmp_le_u32 vcc, 9, v30
    s_nop 1
    v_cndmask_b32 v31, 0, 3, vcc
    v_add_u32 v30, v30, v31
    v_lshlrev_b32 v28, 5, v30
    v_lshrrev_b32 v30, 3, v1
    v_lshl_add_u32 v28, v30, 2, v28
    s_add_u32 s50, s30, 688128
    v_add_u32 v28, s50, v28
    global_load_dword v133, v28, s[28:29] sc1
    v_and_b32 v30, 7, v1
    v_min_u32 v30, 5, v30
    v_add_u32 v30, 6, v30
    v_cmp_le_u32 vcc, 9, v30
    s_nop 1
    v_cndmask_b32 v31, 0, 3, vcc
    v_add_u32 v30, v30, v31
    v_lshlrev_b32 v28, 5, v30
    v_lshrrev_b32 v30, 3, v1
    v_lshl_add_u32 v28, v30, 2, v28
    s_add_u32 s50, s30, 688128
    v_add_u32 v28, s50, v28
    global_load_dword v134, v28, s[28:29] sc1
    v_and_b32 v30, 7, v1
    v_min_u32 v30, 5, v30
    v_add_u32 v30, 12, v30
    v_cmp_le_u32 vcc, 9, v30
    s_nop 1
    v_cndmask_b32 v31, 0, 3, vcc
    v_add_u32 v30, v30, v31
    v_lshlrev_b32 v28, 5, v30
    v_lshrrev_b32 v30, 3, v1
    v_lshl_add_u32 v28, v30, 2, v28
    s_add_u32 s50, s30, 688128
    v_add_u32 v28, s50, v28
    global_load_dword v135, v28, s[28:29] sc1
    v_bfe_u32 v30, v1, 3, 1
    v_lshlrev_b32 v28, 8, v30
    v_lshrrev_b32 v30, 4, v1
    v_lshl_add_u32 v28, v30, 6, v28
    v_and_b32 v30, 7, v1
    v_lshl_add_u32 v28, v30, 3, v28
    v_add_u32 v28, s55, v28
    global_load_dword v128, v28, s[28:29] sc1
    v_bfe_u32 v28, v1, 3, 1
    v_lshlrev_b32 v28, 3, v28
    v_add_u32 v28, s55, v28
    global_load_dword v129, v28, s[28:29] offset:516 sc1
    v_lshrrev_b32 v28, 5, v1
    v_mul_u32_u24 v28, 384, v28
    v_and_b32 v30, 31, v1
    v_lshl_add_u32 v28, v30, 2, v28
    s_add_u32 s49, s70, 458752
    v_add_u32 v28, s49, v28
    global_load_dword v130, v28, s[28:29] offset:0 sc1
    global_load_dword v131, v28, s[28:29] offset:128 sc1
    global_load_dword v132, v28, s[28:29] offset:256 sc1
    s_branch L_SNJ
L_NOSN:
    s_waitcnt vmcnt(9)
L_SNJ:
    s_mov_b32 s53, 2
    s_sub_u32 s51, s40, 4
    s_mul_i32 s51, s51, 2304
    s_add_u32 s51, s51, 9216
L_LN:
    v_lshlrev_b32 v50, 16, v40
    v_and_b32 v51, 0xffff0000, v40
    v_lshlrev_b32 v52, 16, v41
    v_and_b32 v53, 0xffff0000, v41
    v_lshlrev_b32 v54, 16, v42
    v_and_b32 v55, 0xffff0000, v42
    v_lshlrev_b32 v56, 16, v43
    v_and_b32 v57, 0xffff0000, v43
    v_lshlrev_b32 v58, 16, v44
    v_and_b32 v59, 0xffff0000, v44
    v_lshlrev_b32 v60, 16, v45
    v_and_b32 v61, 0xffff0000, v45
    v_lshlrev_b32 v62, 16, v46
    v_and_b32 v63, 0xffff0000, v46
    v_lshlrev_b32 v64, 16, v47
    v_and_b32 v65, 0xffff0000, v47
    v_lshlrev_b32 v66, 16, v48
    v_and_b32 v67, 0xffff0000, v48
    v_add_f32 v28, v50, v51
    v_add_f32 v29, v52, v53
    v_add_f32 v28, v28, v54
    v_add_f32 v29, v29, v55
    v_add_f32 v28, v28, v56
    v_add_f32 v29, v29, v57
    v_add_f32 v28, v28, v58
    v_add_f32 v29, v29, v59
    v_add_f32 v28, v28, v60
    v_add_f32 v29, v29, v61
    v_add_f32 v28, v28, v62
    v_add_f32 v29, v29, v63
    v_add_f32 v28, v28, v64
    v_add_f32 v29, v29, v65
    v_add_f32 v28, v28, v66
    v_add_f32 v29, v29, v67
    v_add_f32 v28, v28, v29
    s_nop 1
    v_add_f32_dpp v28, v28, v28 quad_perm:[1,0,3,2] row_mask:0xf bank_mask:0xf
    s_nop 1
    v_add_f32_dpp v28, v28, v28 quad_perm:[2,3,0,1] row_mask:0xf bank_mask:0xf
    s_nop 1
    v_add_f32_dpp v28, v28, v28 row_half_mirror row_mask:0xf bank_mask:0xf
    s_nop 1
    v_add_f32_dpp v28, v28, v28 row_mirror row_mask:0xf bank_mask:0xf
    v_mov_b32 v29, v28
    s_nop 1
    v_permlane16_swap_b32 v29, v28
    v_add_f32 v28, v29, v28
    v_mul_f32 v28, 0x3ae38e39, v28
    v_mov_b32 v30, 0
    v_mov_b32 v31, 0
    v_sub_f32 v32, v50, v28
    v_sub_f32 v33, v51, v28
    v_fmac_f32 v30, v32, v32
    v_fmac_f32 v31, v33, v33
    v_sub_f32 v32, v52, v28
    v_sub_f32 v33, v53, v28
    v_fmac_f32 v30, v32, v32
    v_fmac_f32 v31, v33, v33
    v_sub_f32 v32, v54, v28
    v_sub_f32 v33, v55, v28
    v_fmac_f32 v30, v32, v32
    v_fmac_f32 v31, v33, v33
    v_sub_f32 v32, v56, v28
    v_sub_f32 v33, v57, v28
    v_fmac_f32 v30, v32, v32
    v_fmac_f32 v31, v33, v33
    v_sub_f32 v32, v58, v28
    v_sub_f32 v33, v59, v28
    v_fmac_f32 v30, v32, v32
    v_fmac_f32 v31, v33, v33
    v_sub_f32 v32, v60, v28
    v_sub_f32 v33, v61, v28
    v_fmac_f32 v30, v32, v32
    v_fmac_f32 v31, v33, v33
    v_sub_f32 v32, v62, v28
    v_sub_f32 v33, v63, v28
    v_fmac_f32 v30, v32, v32
    v_fmac_f32 v31, v33, v33
    v_sub_f32 v32, v64, v28
    v_sub_f32 v33, v65, v28
    v_fmac_f32 v30, v32, v32
    v_fmac_f32 v31, v33, v33
    v_sub_f32 v32, v66, v28
    v_sub_f32 v33, v67, v28
    v_fmac_f32 v30, v32, v32
    v_fmac_f32 v31, v33, v33
    v_add_f32 v30, v30, v31
    s_nop 1
    v_add_f32_dpp v30, v30, v30 quad_perm:[1,0,3,2] row_mask:0xf bank_mask:0xf
    s_nop 1
    v_add_f32_dpp v30, v30, v30 quad_perm:[2,3,0,1] row_mask:0xf bank_mask:0xf
    s_nop 1
    v_add_f32_dpp v30, v30, v30 row_half_mirror row_mask:0xf bank_mask:0xf
    s_nop 1
    v_add_f32_dpp v30, v30, v30 row_mirror row_mask:0xf bank_mask:0xf
    v_mov_b32 v31, v30
    s_nop 1
    v_permlane16_swap_b32 v31, v30
    v_add_f32 v30, v31, v30
    v_mul_f32 v30, 0x3ae38e39, v30
    v_cvt_pk_bf16_f32 v28, v28, v28
    v_lshlrev_b32 v28, 16, v28
    v_cvt_pk_bf16_f32 v30, v30, v30
    v_lshlrev_b32 v30, 16, v30
    v_add_f32 v30, 0x3727c5ac, v30
    v_cvt_pk_bf16_f32 v30, v30, v30
    v_lshlrev_b32 v30, 16, v30
    v_sqrt_f32 v30, v30
    s_nop 0
    v_cvt_pk_bf16_f32 v30, v30, v30
    v_lshlrev_b32 v30, 16, v30
    v_rcp_f32 v30, v30
    v_sub_f32 v50, v50, v28
    v_sub_f32 v51, v51, v28
    v_cvt_pk_bf16_f32 v40, v50, v51
    v_lshlrev_b32 v50, 16, v40
    v_and_b32 v51, 0xffff0000, v40
    v_mul_f32 v50, v50, v30
    v_mul_f32 v51, v51, v30
    v_cvt_pk_bf16_f32 v40, v50, v51
    v_sub_f32 v52, v52, v28
    v_sub_f32 v53, v53, v28
    v_cvt_pk_bf16_f32 v41, v52, v53
    v_lshlrev_b32 v52, 16, v41
    v_and_b32 v53, 0xffff0000, v41
    v_mul_f32 v52, v52, v30
    v_mul_f32 v53, v53, v30
    v_cvt_pk_bf16_f32 v41, v52, v53
    v_sub_f32 v54, v54, v28
    v_sub_f32 v55, v55, v28
    v_cvt_pk_bf16_f32 v42, v54, v55
    v_lshlrev_b32 v54, 16, v42
    v_and_b32 v55, 0xffff0000, v42
    v_mul_f32 v54, v54, v30
    v_mul_f32 v55, v55, v30
    v_cvt_pk_bf16_f32 v42, v54, v55
    v_sub_f32 v56, v56, v28
    v_sub_f32 v57, v57, v28
    v_cvt_pk_bf16_f32 v43, v56, v57
    v_lshlrev_b32 v56, 16, v43
    v_and_b32 v57, 0xffff0000, v43
    v_mul_f32 v56, v56, v30
    v_mul_f32 v57, v57, v30
    v_cvt_pk_bf16_f32 v43, v56, v57
    v_sub_f32 v58, v58, v28
    v_sub_f32 v59, v59, v28
    v_cvt_pk_bf16_f32 v44, v58, v59
    v_lshlrev_b32 v58, 16, v44
    v_and_b32 v59, 0xffff0000, v44
    v_mul_f32 v58, v58, v30
    v_mul_f32 v59, v59, v30
    v_cvt_pk_bf16_f32 v44, v58, v59
    v_sub_f32 v60, v60, v28
    v_sub_f32 v61, v61, v28
    v_cvt_pk_bf16_f32 v45, v60, v61
    v_lshlrev_b32 v60, 16, v45
    v_and_b32 v61, 0xffff0000, v45
    v_mul_f32 v60, v60, v30
    v_mul_f32 v61, v61, v30
    v_cvt_pk_bf16_f32 v45, v60, v61
    v_sub_f32 v62, v62, v28
    v_sub_f32 v63, v63, v28
    v_cvt_pk_bf16_f32 v46, v62, v63
    v_lshlrev_b32 v62, 16, v46
    v_and_b32 v63, 0xffff0000, v46
    v_mul_f32 v62, v62, v30
    v_mul_f32 v63, v63, v30
    v_cvt_pk_bf16_f32 v46, v62, v63
    v_sub_f32 v64, v64, v28
    v_sub_f32 v65, v65, v28
    v_cvt_pk_bf16_f32 v47, v64, v65
    v_lshlrev_b32 v64, 16, v47
    v_and_b32 v65, 0xffff0000, v47
    v_mul_f32 v64, v64, v30
    v_mul_f32 v65, v65, v30
    v_cvt_pk_bf16_f32 v47, v64, v65
    v_sub_f32 v66, v66, v28
    v_sub_f32 v67, v67, v28
    v_cvt_pk_bf16_f32 v48, v66, v67
    v_lshlrev_b32 v66, 16, v48
    v_and_b32 v67, 0xffff0000, v48
    v_mul_f32 v66, v66, v30
    v_mul_f32 v67, v67, v30
    v_cvt_pk_bf16_f32 v48, v66, v67
    s_sub_u32 s53, s53, 1
    s_cmp_lg_u32 s53, 0
    s_cbranch_scc1 L_LN
    v_add_u32 v3, s51, v3
    ds_write_b32 v3, v40 offset:0
    ds_write_b32 v3, v41 offset:128
    ds_write_b32 v3, v42 offset:256
    ds_write_b32 v3, v43 offset:384
    ds_write_b32 v3, v44 offset:512
    ds_write_b32 v3, v45 offset:640
    ds_write_b32 v3, v46 offset:768
    ds_write_b32 v3, v47 offset:896
    ds_write_b32 v3, v48 offset:1024
    s_cmp_lg_u32 s40, 0
    s_cbranch_scc1 L_BBR
    s_waitcnt vmcnt(17)
    ds_write_b128 v2, v[96:99] offset:36928
    s_waitcnt vmcnt(16)
    ds_write_b128 v2, v[100:103] offset:37952
    s_waitcnt vmcnt(15)
    ds_write_b128 v2, v[104:107] offset:38976
    s_waitcnt vmcnt(14)
    ds_write_b128 v2, v[108:111] offset:40000
    s_waitcnt vmcnt(13)
    ds_write_b128 v2, v[112:115] offset:41024
    s_waitcnt vmcnt(12)
    ds_write_b128 v2, v[116:119] offset:42048
    s_waitcnt vmcnt(11)
    ds_write_b128 v2, v[120:123] offset:43072
    s_waitcnt vmcnt(10)
    ds_write_b128 v2, v[124:127] offset:44096
    s_waitcnt vmcnt(9)
    ds_write_b128 v2, v[128:131] offset:45120
    s_waitcnt vmcnt(8)
    ds_write_b128 v2, v[132:135] offset:46144
    s_waitcnt vmcnt(7)
    ds_write_b128 v2, v[136:139] offset:47168
    s_waitcnt vmcnt(6)
    ds_write_b128 v2, v[140:143] offset:48192
    s_waitcnt vmcnt(5)
    ds_write_b128 v2, v[144:147] offset:49216
    s_waitcnt vmcnt(4)
    ds_write_b128 v2, v[148:151] offset:50240
    s_waitcnt vmcnt(3)
    ds_write_b128 v2, v[152:155] offset:51264
    s_waitcnt vmcnt(2)
    ds_write_b128 v2, v[156:159] offset:52288
    s_waitcnt vmcnt(1)
    ds_write_b128 v2, v[160:163] offset:53312
    s_waitcnt vmcnt(0)
    ds_write_b128 v2, v[164:167] offset:54336
    v_lshrrev_b32 v28, 4, v1
    v_lshrrev_b32 v29, 2, v1
    v_lshlrev_b32 v29, 7, v29
    v_and_b32 v30, 3, v1
    v_lshl_add_u32 v29, v30, 3, v29
    v_and_b32 v30, 1, v1
    v_mul_u32_u24 v30, 1152, v30
    v_lshl_add_u32 v30, v28, 3, v30
    s_lshr_b32 s49, s44, 2
    s_mul_i32 s49, s49, 288
    v_add_u32 v30, s49, v30
    s_waitcnt lgkmcnt(0)
    ds_read_b64_tr_b16 v[96:97], v29 offset:36928
    ds_read_b64_tr_b16 v[98:99], v29 offset:36960
    ds_read_b64_tr_b16 v[100:101], v29 offset:36992
    ds_read_b64_tr_b16 v[102:103], v29 offset:37024
    ds_read_b64 v[104:105], v30 offset:9216
    ds_read_b64_tr_b16 v[106:107], v29 offset:38976
    ds_read_b64_tr_b16 v[108:109], v29 offset:39008
    ds_read_b64_tr_b16 v[110:111], v29 offset:39040
    ds_read_b64_tr_b16 v[112:113], v29 offset:39072
    ds_read_b64 v[114:115], v30 offset:9248
    ds_read_b64_tr_b16 v[116:117], v29 offset:41024
    ds_read_b64_tr_b16 v[118:119], v29 offset:41056
    ds_read_b64_tr_b16 v[120:121], v29 offset:41088
    ds_read_b64_tr_b16 v[122:123], v29 offset:41120
    ds_read_b64 v[124:125], v30 offset:9280
    s_waitcnt lgkmcnt(10)
    v_mfma_f32_16x16x16_bf16 v[52:55], v[104:105], v[96:97], 0
    v_mfma_f32_16x16x16_bf16 v[56:59], v[104:105], v[98:99], 0
    v_mfma_f32_16x16x16_bf16 v[60:63], v[104:105], v[100:101], 0
    v_mfma_f32_16x16x16_bf16 v[64:67], v[104:105], v[102:103], 0
    ds_read_b64_tr_b16 v[126:127], v29 offset:43072
    ds_read_b64_tr_b16 v[128:129], v29 offset:43104
    ds_read_b64_tr_b16 v[130:131], v29 offset:43136
    ds_read_b64_tr_b16 v[132:133], v29 offset:43168
    ds_read_b64 v[134:135], v30 offset:9312
    s_waitcnt lgkmcnt(10)
    v_mfma_f32_16x16x16_bf16 v[52:55], v[114:115], v[106:107], v[52:55]
    v_mfma_f32_16x16x16_bf16 v[56:59], v[114:115], v[108:109], v[56:59]
    v_mfma_f32_16x16x16_bf16 v[60:63], v[114:115], v[110:111], v[60:63]
    v_mfma_f32_16x16x16_bf16 v[64:67], v[114:115], v[112:113], v[64:67]
    ds_read_b64_tr_b16 v[96:97], v29 offset:45120
    ds_read_b64_tr_b16 v[98:99], v29 offset:45152
    ds_read_b64_tr_b16 v[100:101], v29 offset:45184
    ds_read_b64_tr_b16 v[102:103], v29 offset:45216
    ds_read_b64 v[104:105], v30 offset:9344
    s_waitcnt lgkmcnt(10)
    v_mfma_f32_16x16x16_bf16 v[52:55], v[124:125], v[116:117], v[52:55]
    v_mfma_f32_16x16x16_bf16 v[56:59], v[124:125], v[118:119], v[56:59]
    v_mfma_f32_16x16x16_bf16 v[60:63], v[124:125], v[120:121], v[60:63]
    v_mfma_f32_16x16x16_bf16 v[64:67], v[124:125], v[122:123], v[64:67]
    ds_read_b64_tr_b16 v[106:107], v29 offset:47168
    ds_read_b64_tr_b16 v[108:109], v29 offset:47200
    ds_read_b64_tr_b16 v[110:111], v29 offset:47232
    ds_read_b64_tr_b16 v[112:113], v29 offset:47264
    ds_read_b64 v[114:115], v30 offset:9376
    s_waitcnt lgkmcnt(10)
    v_mfma_f32_16x16x16_bf16 v[52:55], v[134:135], v[126:127], v[52:55]
    v_mfma_f32_16x16x16_bf16 v[56:59], v[134:135], v[128:129], v[56:59]
    v_mfma_f32_16x16x16_bf16 v[60:63], v[134:135], v[130:131], v[60:63]
    v_mfma_f32_16x16x16_bf16 v[64:67], v[134:135], v[132:133], v[64:67]
    ds_read_b64_tr_b16 v[116:117], v29 offset:49216
    ds_read_b64_tr_b16 v[118:119], v29 offset:49248
    ds_read_b64_tr_b16 v[120:121], v29 offset:49280
    ds_read_b64_tr_b16 v[122:123], v29 offset:49312
    ds_read_b64 v[124:125], v30 offset:9408
    s_waitcnt lgkmcnt(10)
    v_mfma_f32_16x16x16_bf16 v[52:55], v[104:105], v[96:97], v[52:55]
    v_mfma_f32_16x16x16_bf16 v[56:59], v[104:105], v[98:99], v[56:59]
    v_mfma_f32_16x16x16_bf16 v[60:63], v[104:105], v[100:101], v[60:63]
    v_mfma_f32_16x16x16_bf16 v[64:67], v[104:105], v[102:103], v[64:67]
    ds_read_b64_tr_b16 v[126:127], v29 offset:51264
    ds_read_b64_tr_b16 v[128:129], v29 offset:51296
    ds_read_b64_tr_b16 v[130:131], v29 offset:51328
    ds_read_b64_tr_b16 v[132:133], v29 offset:51360
    ds_read_b64 v[134:135], v30 offset:9440
    s_waitcnt lgkmcnt(10)
    v_mfma_f32_16x16x16_bf16 v[52:55], v[114:115], v[106:107], v[52:55]
    v_mfma_f32_16x16x16_bf16 v[56:59], v[114:115], v[108:109], v[56:59]
    v_mfma_f32_16x16x16_bf16 v[60:63], v[114:115], v[110:111], v[60:63]
    v_mfma_f32_16x16x16_bf16 v[64:67], v[114:115], v[112:113], v[64:67]
    ds_read_b64_tr_b16 v[96:97], v29 offset:53312
    ds_read_b64_tr_b16 v[98:99], v29 offset:53344
    ds_read_b64_tr_b16 v[100:101], v29 offset:53376
    ds_read_b64_tr_b16 v[102:103], v29 offset:53408
    ds_read_b64 v[104:105], v30 offset:9472
    s_waitcnt lgkmcnt(10)
    v_mfma_f32_16x16x16_bf16 v[52:55], v[124:125], v[116:117], v[52:55]
    v_mfma_f32_16x16x16_bf16 v[56:59], v[124:125], v[118:119], v[56:59]
    v_mfma_f32_16x16x16_bf16 v[60:63], v[124:125], v[120:121], v[60:63]
    v_mfma_f32_16x16x16_bf16 v[64:67], v[124:125], v[122:123], v[64:67]
    s_waitcnt lgkmcnt(5)
    v_mfma_f32_16x16x16_bf16 v[52:55], v[134:135], v[126:127], v[52:55]
    v_mfma_f32_16x16x16_bf16 v[56:59], v[134:135], v[128:129], v[56:59]
    v_mfma_f32_16x16x16_bf16 v[60:63], v[134:135], v[130:131], v[60:63]
    v_mfma_f32_16x16x16_bf16 v[64:67], v[134:135], v[132:133], v[64:67]
    s_waitcnt lgkmcnt(0)
    v_mfma_f32_16x16x16_bf16 v[52:55], v[104:105], v[96:97], v[52:55]
    v_mfma_f32_16x16x16_bf16 v[56:59], v[104:105], v[98:99], v[56:59]
    v_mfma_f32_16x16x16_bf16 v[60:63], v[104:105], v[100:101], v[60:63]
    v_mfma_f32_16x16x16_bf16 v[64:67], v[104:105], v[102:103], v[64:67]
    s_mul_i32 s49, s41, 8192
    s_mul_i32 s50, s44, 256
    s_add_u32 s49, s49, s50
    v_lshlrev_b32 v28, 4, v1
    v_add_u32 v32, s49, v28
    v_add_u32 v33, 4096, v32
    v_mov_b32 v4, v52
    v_mov_b32 v5, v56
    v_mov_b32 v6, v60
    v_mov_b32 v7, v64
    v_mov_b32 v8, v53
    v_mov_b32 v9, v57
    v_mov_b32 v10, v61
    v_mov_b32 v11, v65
    s_mov_b64 exec, 0xffff
    global_store_dwordx4 v32, v[4:7], s[28:29]
    global_store_dwordx4 v33, v[8:11], s[28:29]
    s_mov_b64 exec, -1
    s_lshl_b32 s49, s41, 4
    s_mov_b32 s50, 1
    s_mov_b32 s51, s58
    s_waitcnt vmcnt(0) lgkmcnt(0)
    v_mov_b32 v31, 36
    s_mov_b32 s52, 131072
    s_nop 0
L_SNW:
    ds_read_b32 v28, v31
    s_waitcnt lgkmcnt(0)
    v_readfirstlane_b32 s50, v28
    s_nop 0
    s_cmp_eq_u32 s50, 1
    s_cbranch_scc1 L_SNW_OK
    s_sleep 1
    s_sub_u32 s52, s52, 1
    s_cmp_lg_u32 s52, 0
    s_cbranch_scc1 L_SNW
L_SNW_OK:
    s_mov_b32 s50, 1
    s_getreg_b32 s75, hwreg(HW_REG_XCC_ID)
    s_and_b32 s75, s75, 15
    s_mul_i32 s50, s75, s75
    s_lshl_b32 s50, s50, 8
    s_add_u32 s50, s50, s75
    s_lshl_b32 s50, s50, 8
    s_add_u32 s50, s50, 1
    s_mul_i32 s75, s50, 15
    s_atomic_add s50, s[26:27], s49 glc
    s_waitcnt lgkmcnt(0)
    s_cmp_eq_u32 s50, s75
    s_cselect_b32 s74, 1, 2
    s_and_b32 s50, s50, 0xff
    s_cmp_lg_u32 s50, 15
    s_cbranch_scc1 L_NOTMASTER
    s_mul_i32 s49, s41, 10240
    s_add_u32 s49, s49, 262672
    s_add_u32 s56, s28, s49
    s_addc_u32 s57, s29, 0
    s_mov_b32 s50, s74
    s_atomic_add s50, s[56:57], 0
    s_atomic_add s50, s[56:57], 640
    s_atomic_add s50, s[56:57], 1280
    s_atomic_add s50, s[56:57], 1920
    s_atomic_add s50, s[56:57], 2560
    s_atomic_add s50, s[56:57], 3200
    s_atomic_add s50, s[56:57], 3840
    s_atomic_add s50, s[56:57], 4480
    s_atomic_add s50, s[56:57], 5120
    s_atomic_add s50, s[56:57], 5760
    s_atomic_add s50, s[56:57], 6400
    s_atomic_add s50, s[56:57], 7040
    s_atomic_add s50, s[56:57], 7680
    s_atomic_add s50, s[56:57], 8320
    s_atomic_add s50, s[56:57], 8960
    s_atomic_add s50, s[56:57], 9600
    s_branch L_POLLA_OK
L_NOTMASTER:
    s_mov_b32 s52, 32768
L_POLLA:
    s_load_dword s50, s[28:29], s51 glc
    s_waitcnt lgkmcnt(0)
    s_sub_u32 s74, s50, s73
    s_cmp_lg_u32 s74, 0
    s_cbranch_scc1 L_POLLA_OK
    s_sleep 2
    s_sub_u32 s52, s52, 1
    s_cmp_lg_u32 s52, 0
    s_cbranch_scc1 L_POLLA
L_POLLA_OK:
    s_cmp_eq_u32 s74, 1
    s_cbranch_scc1 L_QOK
    s_mov_b64 exec, 0xffff
    global_store_dwordx4 v32, v[4:7], s[28:29] sc1
    global_store_dwordx4 v33, v[8:11], s[28:29] sc1
    s_mov_b64 exec, -1
    s_lshl_b32 s49, s41, 4
    s_add_u32 s49, s49, 4
    s_mov_b32 s50, 1
    s_waitcnt vmcnt(0)
    s_atomic_add s50, s[26:27], s49 glc
    s_waitcnt lgkmcnt(0)
    s_cmp_lg_u32 s50, 15
    s_cbranch_scc1 L_NOTM2
    s_mul_i32 s49, s41, 10240
    s_add_u32 s49, s49, 262672
    s_add_u32 s56, s28, s49
    s_addc_u32 s57, s29, 0
    s_mov_b32 s50, 1
    s_atomic_add s50, s[56:57], 0
    s_atomic_add s50, s[56:57], 640
    s_atomic_add s50, s[56:57], 1280
    s_atomic_add s50, s[56:57], 1920
    s_atomic_add s50, s[56:57], 2560
    s_atomic_add s50, s[56:57], 3200
    s_atomic_add s50, s[56:57], 3840
    s_atomic_add s50, s[56:57], 4480
    s_atomic_add s50, s[56:57], 5120
    s_atomic_add s50, s[56:57], 5760
    s_atomic_add s50, s[56:57], 6400
    s_atomic_add s50, s[56:57], 7040
    s_atomic_add s50, s[56:57], 7680
    s_atomic_add s50, s[56:57], 8320
    s_atomic_add s50, s[56:57], 8960
    s_atomic_add s50, s[56:57], 9600
    s_branch L_QOK
L_NOTM2:
    s_mov_b32 s52, 32768
    s_add_u32 s73, s73, 3
L_POLL2:
    s_load_dword s50, s[28:29], s51 glc
    s_waitcnt lgkmcnt(0)
    s_cmp_eq_u32 s50, s73
    s_cbranch_scc1 L_QOK
    s_sleep 2
    s_sub_u32 s52, s52, 1
    s_cmp_lg_u32 s52, 0
    s_cbranch_scc1 L_POLL2
L_QOK:
    s_mul_i32 s49, s41, 8192
    s_mul_i32 s50, s42, 4096
    s_add_u32 s49, s49, s50
    v_add_u32 v28, s49, v2
    global_load_dwordx4 v[128:131], v28, s[28:29] offset:0 sc1
    global_load_dwordx4 v[132:135], v28, s[28:29] offset:1024 sc1
    global_load_dwordx4 v[136:139], v28, s[28:29] offset:2048 sc1
    global_load_dwordx4 v[140:143], v28, s[28:29] offset:3072 sc1
    v_lshrrev_b32 v30, 4, v1
    v_lshlrev_b32 v30, 7, v30
    v_and_b32 v31, 15, v1
    v_lshl_add_u32 v30, v31, 1, v30
    s_waitcnt vmcnt(2)
    v_add_f32 v128, v128, v132
    v_add_f32 v129, v129, v133
    v_add_f32 v130, v130, v134
    v_add_f32 v131, v131, v135
    s_waitcnt vmcnt(1)
    v_add_f32 v128, v128, v136
    v_add_f32 v129, v129, v137
    v_add_f32 v130, v130, v138
    v_add_f32 v131, v131, v139
    s_waitcnt vmcnt(0)
    v_add_f32 v128, v128, v140
    v_add_f32 v129, v129, v141
    v_add_f32 v130, v130, v142
    v_add_f32 v131, v131, v143
    v_cvt_pk_bf16_f32 v128, v128, v129
    v_cvt_pk_bf16_f32 v129, v130, v131
    ds_write_b16 v30, v128 offset:256
    ds_write_b16_d16_hi v30, v128 offset:288
    ds_write_b16 v30, v129 offset:320
    ds_write_b16_d16_hi v30, v129 offset:352
    s_cmp_eq_u32 s74, 1
    s_cselect_b32 s74, 1, 2
    v_mov_b32 v30, s74
    v_mov_b32 v31, 0
    s_waitcnt lgkmcnt(0)
    ds_write_b32 v31, v30
    s_setprio 0
    s_branch L_STREAM
L_BBR:
    s_waitcnt vmcnt(0)
    s_cmp_lg_u32 s40, 5
    s_cbranch_scc1 L_NOPK
    v_mov_b32 v0, 0
    v_alignbit_b32 v0, v100, v0, 1
    v_alignbit_b32 v0, v102, v0, 1
    v_alignbit_b32 v0, v104, v0, 1
    v_alignbit_b32 v0, v106, v0, 1
    v_alignbit_b32 v0, v108, v0, 1
    v_alignbit_b32 v0, v110, v0, 1
    v_alignbit_b32 v0, v112, v0, 1
    v_alignbit_b32 v0, v114, v0, 1
    v_alignbit_b32 v0, v117, v0, 1
    v_alignbit_b32 v0, v119, v0, 1
    v_alignbit_b32 v0, v121, v0, 1
    v_alignbit_b32 v0, v123, v0, 1
    v_alignbit_b32 v0, v124, v0, 1
    v_alignbit_b32 v0, v125, v0, 1
    v_alignbit_b32 v0, v126, v0, 1
    v_alignbit_b32 v0, v127, v0, 1
    v_alignbit_b32 v0, v128, v0, 1
    v_alignbit_b32 v0, v129, v0, 1
    v_alignbit_b32 v0, v130, v0, 1
    v_alignbit_b32 v0, v131, v0, 1
    v_alignbit_b32 v0, v132, v0, 1
    v_alignbit_b32 v0, v133, v0, 1
    v_alignbit_b32 v0, v134, v0, 1
    v_alignbit_b32 v0, v135, v0, 1
    v_alignbit_b32 v0, v136, v0, 1
    v_alignbit_b32 v0, v137, v0, 1
    v_alignbit_b32 v0, v138, v0, 1
    v_alignbit_b32 v0, v139, v0, 1
    v_lshrrev_b32 v0, 4, v0
    v_not_b32 v0, v0
    v_lshlrev_b32 v29, 2, v1
    ds_write_b32 v29, v0 offset:768
    v_mov_b32 v28, 36
    v_mov_b32 v29, 1
    ds_write_b32 v28, v29
    s_nop 0
L_NOPK:
    v_lshlrev_b32 v100, 16, v70
    v_and_b32 v101, 0xffff0000, v70
    v_lshlrev_b32 v118, 16, v80
    v_and_b32 v119, 0xffff0000, v80
    v_lshlrev_b32 v102, 16, v71
    v_and_b32 v103, 0xffff0000, v71
    v_lshlrev_b32 v120, 16, v81
    v_and_b32 v121, 0xffff0000, v81
    v_lshlrev_b32 v104, 16, v72
    v_and_b32 v105, 0xffff0000, v72
    v_lshlrev_b32 v122, 16, v82
    v_and_b32 v123, 0xffff0000, v82
    v_lshlrev_b32 v106, 16, v73
    v_and_b32 v107, 0xffff0000, v73
    v_lshlrev_b32 v124, 16, v83
    v_and_b32 v125, 0xffff0000, v83
    v_lshlrev_b32 v108, 16, v74
    v_and_b32 v109, 0xffff0000, v74
    v_lshlrev_b32 v126, 16, v84
    v_and_b32 v127, 0xffff0000, v84
    v_lshlrev_b32 v110, 16, v75
    v_and_b32 v111, 0xffff0000, v75
    v_lshlrev_b32 v128, 16, v85
    v_and_b32 v129, 0xffff0000, v85
    v_lshlrev_b32 v112, 16, v76
    v_and_b32 v113, 0xffff0000, v76
    v_lshlrev_b32 v130, 16, v86
    v_and_b32 v131, 0xffff0000, v86
    v_lshlrev_b32 v114, 16, v77
    v_and_b32 v115, 0xffff0000, v77
    v_lshlrev_b32 v132, 16, v87
    v_and_b32 v133, 0xffff0000, v87
    v_lshlrev_b32 v116, 16, v78
    v_and_b32 v117, 0xffff0000, v78
    v_lshlrev_b32 v134, 16, v88
    v_and_b32 v135, 0xffff0000, v88
    v_mov_b32 v156, 0xbdd2d3e8
    v_mov_b32 v158, 0xc0135761
    v_mov_b32 v160, 1.0
    v_mov_b32 v157, 0xbdd2d3e8
    v_mov_b32 v159, 0xc0135761
    v_mov_b32 v161, 1.0
    v_and_b32 v166, 7, v1
    s_sub_u32 s49, s40, 5
    s_mul_i32 s49, s49, 6
    s_mul_i32 s50, s3, 144
    s_add_u32 s51, s51, s50
    v_lshrrev_b32 v164, 3, v1
    v_lshlrev_b32 v164, 1, v164
    v_add_u32 v164, s51, v164
    s_mov_b32 s53, 0
    v_mov_b32 v154, 0
    s_setprio 0
    s_nop 0
L_BLOOP:
    s_add_u32 s50, s49, s53
    s_cmp_ge_u32 s50, 9
    s_cselect_b32 s51, 63, 0
    s_add_u32 s50, s50, s51
    s_lshl_b32 s50, s50, 4
    v_add_u32 v163, s50, v164
    ds_read_u16 v162, v163
    s_waitcnt lgkmcnt(0)
    v_lshlrev_b32 v162, 16, v162
    v_mov_b32 v163, v162
    v_pk_mul_f32 v[136:137], v[162:163], v[100:101]
    v_pk_mul_f32 v[138:139], v[162:163], v[102:103]
    v_pk_mul_f32 v[140:141], v[162:163], v[104:105]
    v_pk_mul_f32 v[142:143], v[162:163], v[106:107]
    v_pk_mul_f32 v[144:145], v[162:163], v[108:109]
    v_pk_mul_f32 v[146:147], v[162:163], v[110:111]
    v_pk_mul_f32 v[148:149], v[162:163], v[112:113]
    v_pk_mul_f32 v[150:151], v[162:163], v[114:115]
    v_pk_mul_f32 v[152:153], v[162:163], v[116:117]
    v_cvt_pk_bf16_f32 v40, v136, v137
    v_cvt_pk_bf16_f32 v41, v138, v139
    v_cvt_pk_bf16_f32 v42, v140, v141
    v_cvt_pk_bf16_f32 v43, v142, v143
    v_cvt_pk_bf16_f32 v44, v144, v145
    v_cvt_pk_bf16_f32 v45, v146, v147
    v_cvt_pk_bf16_f32 v46, v148, v149
    v_cvt_pk_bf16_f32 v47, v150, v151
    v_cvt_pk_bf16_f32 v48, v152, v153
    v_lshlrev_b32 v136, 16, v40
    v_and_b32 v137, 0xffff0000, v40
    v_lshlrev_b32 v138, 16, v41
    v_and_b32 v139, 0xffff0000, v41
    v_lshlrev_b32 v140, 16, v42
    v_and_b32 v141, 0xffff0000, v42
    v_lshlrev_b32 v142, 16, v43
    v_and_b32 v143, 0xffff0000, v43
    v_lshlrev_b32 v144, 16, v44
    v_and_b32 v145, 0xffff0000, v44
    v_lshlrev_b32 v146, 16, v45
    v_and_b32 v147, 0xffff0000, v45
    v_lshlrev_b32 v148, 16, v46
    v_and_b32 v149, 0xffff0000, v46
    v_lshlrev_b32 v150, 16, v47
    v_and_b32 v151, 0xffff0000, v47
    v_lshlrev_b32 v152, 16, v48
    v_and_b32 v153, 0xffff0000, v48
    v_pk_add_f32 v[136:137], v[136:137], v[118:119]
    v_pk_add_f32 v[138:139], v[138:139], v[120:121]
    v_pk_add_f32 v[140:141], v[140:141], v[122:123]
    v_pk_add_f32 v[142:143], v[142:143], v[124:125]
    v_pk_add_f32 v[144:145], v[144:145], v[126:127]
    v_pk_add_f32 v[146:147], v[146:147], v[128:129]
    v_pk_add_f32 v[148:149], v[148:149], v[130:131]
    v_pk_add_f32 v[150:151], v[150:151], v[132:133]
    v_pk_add_f32 v[152:153], v[152:153], v[134:135]
    v_cvt_pk_bf16_f32 v40, v136, v137
    v_cvt_pk_bf16_f32 v41, v138, v139
    v_cvt_pk_bf16_f32 v42, v140, v141
    v_cvt_pk_bf16_f32 v43, v142, v143
    v_cvt_pk_bf16_f32 v44, v144, v145
    v_cvt_pk_bf16_f32 v45, v146, v147
    v_cvt_pk_bf16_f32 v46, v148, v149
    v_cvt_pk_bf16_f32 v47, v150, v151
    v_cvt_pk_bf16_f32 v48, v152, v153
    v_lshlrev_b32 v136, 16, v40
    v_and_b32 v137, 0xffff0000, v40
    v_lshlrev_b32 v138, 16, v41
    v_and_b32 v139, 0xffff0000, v41
    v_lshlrev_b32 v140, 16, v42
    v_and_b32 v141, 0xffff0000, v42
    v_lshlrev_b32 v142, 16, v43
    v_and_b32 v143, 0xffff0000, v43
    v_lshlrev_b32 v144, 16, v44
    v_and_b32 v145, 0xffff0000, v44
    v_lshlrev_b32 v146, 16, v45
    v_and_b32 v147, 0xffff0000, v45
    v_lshlrev_b32 v148, 16, v46
    v_and_b32 v149, 0xffff0000, v46
    v_lshlrev_b32 v150, 16, v47
    v_and_b32 v151, 0xffff0000, v47
    v_lshlrev_b32 v152, 16, v48
    v_and_b32 v153, 0xffff0000, v48
    v_pk_mul_f32 v[50:51], v[136:137], v[136:137]
    v_pk_mul_f32 v[52:53], v[138:139], v[138:139]
    v_pk_mul_f32 v[54:55], v[140:141], v[140:141]
    v_pk_mul_f32 v[56:57], v[142:143], v[142:143]
    v_pk_mul_f32 v[58:59], v[144:145], v[144:145]
    v_pk_mul_f32 v[60:61], v[146:147], v[146:147]
    v_pk_mul_f32 v[62:63], v[148:149], v[148:149]
    v_pk_mul_f32 v[64:65], v[150:151], v[150:151]
    v_pk_mul_f32 v[66:67], v[152:153], v[152:153]
    v_pk_fma_f32 v[50:51], v[50:51], v[156:157], v[158:159]
    v_pk_fma_f32 v[52:53], v[52:53], v[156:157], v[158:159]
    v_pk_fma_f32 v[54:55], v[54:55], v[156:157], v[158:159]
    v_pk_fma_f32 v[56:57], v[56:57], v[156:157], v[158:159]
    v_pk_fma_f32 v[58:59], v[58:59], v[156:157], v[158:159]
    v_pk_fma_f32 v[60:61], v[60:61], v[156:157], v[158:159]
    v_pk_fma_f32 v[62:63], v[62:63], v[156:157], v[158:159]
    v_pk_fma_f32 v[64:65], v[64:65], v[156:157], v[158:159]
    v_pk_fma_f32 v[66:67], v[66:67], v[156:157], v[158:159]
    v_pk_mul_f32 v[50:51], v[50:51], v[136:137]
    v_pk_mul_f32 v[52:53], v[52:53], v[138:139]
    v_pk_mul_f32 v[54:55], v[54:55], v[140:141]
    v_pk_mul_f32 v[56:57], v[56:57], v[142:143]
    v_pk_mul_f32 v[58:59], v[58:59], v[144:145]
    v_pk_mul_f32 v[60:61], v[60:61], v[146:147]
    v_pk_mul_f32 v[62:63], v[62:63], v[148:149]
    v_pk_mul_f32 v[64:65], v[64:65], v[150:151]
    v_pk_mul_f32 v[66:67], v[66:67], v[152:153]
    v_exp_f32 v50, v50
    v_exp_f32 v51, v51
    v_exp_f32 v52, v52
    v_exp_f32 v53, v53
    v_exp_f32 v54, v54
    v_exp_f32 v55, v55
    v_exp_f32 v56, v56
    v_exp_f32 v57, v57
    v_exp_f32 v58, v58
    v_exp_f32 v59, v59
    v_exp_f32 v60, v60
    v_exp_f32 v61, v61
    v_exp_f32 v62, v62
    v_exp_f32 v63, v63
    v_exp_f32 v64, v64
    v_exp_f32 v65, v65
    v_exp_f32 v66, v66
    v_exp_f32 v67, v67
    v_pk_add_f32 v[50:51], v[50:51], v[160:161]
    v_pk_add_f32 v[52:53], v[52:53], v[160:161]
    v_pk_add_f32 v[54:55], v[54:55], v[160:161]
    v_pk_add_f32 v[56:57], v[56:57], v[160:161]
    v_pk_add_f32 v[58:59], v[58:59], v[160:161]
    v_pk_add_f32 v[60:61], v[60:61], v[160:161]
    v_pk_add_f32 v[62:63], v[62:63], v[160:161]
    v_pk_add_f32 v[64:65], v[64:65], v[160:161]
    v_pk_add_f32 v[66:67], v[66:67], v[160:161]
    v_rcp_f32 v50, v50
    v_rcp_f32 v51, v51
    v_rcp_f32 v52, v52
    v_rcp_f32 v53, v53
    v_rcp_f32 v54, v54
    v_rcp_f32 v55, v55
    v_rcp_f32 v56, v56
    v_rcp_f32 v57, v57
    v_rcp_f32 v58, v58
    v_rcp_f32 v59, v59
    v_rcp_f32 v60, v60
    v_rcp_f32 v61, v61
    v_rcp_f32 v62, v62
    v_rcp_f32 v63, v63
    v_rcp_f32 v64, v64
    v_rcp_f32 v65, v65
    v_rcp_f32 v66, v66
    v_rcp_f32 v67, v67
    v_pk_mul_f32 v[136:137], v[136:137], v[50:51]
    v_pk_mul_f32 v[138:139], v[138:139], v[52:53]
    v_pk_mul_f32 v[140:141], v[140:141], v[54:55]
    v_pk_mul_f32 v[142:143], v[142:143], v[56:57]
    v_pk_mul_f32 v[144:145], v[144:145], v[58:59]
    v_pk_mul_f32 v[146:147], v[146:147], v[60:61]
    v_pk_mul_f32 v[148:149], v[148:149], v[62:63]
    v_pk_mul_f32 v[150:151], v[150:151], v[64:65]
    v_pk_mul_f32 v[152:153], v[152:153], v[66:67]
    v_cvt_pk_bf16_f32 v40, v136, v137
    v_cvt_pk_bf16_f32 v41, v138, v139
    v_cvt_pk_bf16_f32 v42, v140, v141
    v_cvt_pk_bf16_f32 v43, v142, v143
    v_cvt_pk_bf16_f32 v44, v144, v145
    v_cvt_pk_bf16_f32 v45, v146, v147
    v_cvt_pk_bf16_f32 v46, v148, v149
    v_cvt_pk_bf16_f32 v47, v150, v151
    v_cvt_pk_bf16_f32 v48, v152, v153
    v_mov_b32 v165, 0
    v_dot2c_f32_bf16 v165, v40, v90
    v_dot2c_f32_bf16 v165, v41, v91
    v_dot2c_f32_bf16 v165, v42, v92
    v_dot2c_f32_bf16 v165, v43, v93
    v_dot2c_f32_bf16 v165, v44, v94
    v_dot2c_f32_bf16 v165, v45, v95
    v_dot2c_f32_bf16 v165, v46, v96
    v_dot2c_f32_bf16 v165, v47, v97
    v_dot2c_f32_bf16 v165, v48, v98
    s_nop 2
    v_add_f32_dpp v165, v165, v165 quad_perm:[1,0,3,2] row_mask:0xf bank_mask:0xf
    s_nop 1
    v_add_f32_dpp v165, v165, v165 quad_perm:[2,3,0,1] row_mask:0xf bank_mask:0xf
    s_nop 1
    v_add_f32_dpp v165, v165, v165 row_half_mirror row_mask:0xf bank_mask:0xf
    v_cmp_eq_u32 vcc, s53, v166
    s_nop 1
    v_cndmask_b32 v154, v154, v165, vcc
    s_add_u32 s53, s53, 1
    s_cmp_lt_u32 s53, 6
    s_cbranch_scc1 L_BLOOP
    v_mov_b32 v3, v154
    s_nop 1
L_STREAM:
    v_mov_b32 v38, 0
    s_xor_b32 s49, s48, 0
    buffer_load_dwordx4 v[40:43], v2, s[32:35], s49 offen nt
    s_xor_b32 s49, s48, 4096
    buffer_load_dwordx4 v[44:47], v2, s[32:35], s49 offen nt
    s_xor_b32 s49, s48, 8192
    buffer_load_dwordx4 v[48:51], v2, s[32:35], s49 offen nt
    s_xor_b32 s49, s48, 12288
    buffer_load_dwordx4 v[52:55], v2, s[32:35], s49 offen nt
    s_xor_b32 s49, s48, 16384
    buffer_load_dwordx4 v[56:59], v2, s[32:35], s49 offen nt
    s_xor_b32 s49, s48, 20480
    buffer_load_dwordx4 v[60:63], v2, s[32:35], s49 offen nt
    s_xor_b32 s49, s48, 24576
    buffer_load_dwordx4 v[64:67], v2, s[32:35], s49 offen nt
    s_xor_b32 s49, s48, 28672
    buffer_load_dwordx4 v[68:71], v2, s[32:35], s49 offen nt
L_BDONE:
    s_xor_b32 s49, s48, 32768
    buffer_load_dwordx4 v[72:75], v2, s[32:35], s49 offen nt
    s_xor_b32 s49, s48, 36864
    buffer_load_dwordx4 v[76:79], v2, s[32:35], s49 offen nt
    s_xor_b32 s49, s48, 40960
    buffer_load_dwordx4 v[80:83], v2, s[32:35], s49 offen nt
    s_xor_b32 s49, s48, 45056
    buffer_load_dwordx4 v[84:87], v2, s[32:35], s49 offen nt
    s_xor_b32 s49, s48, 49152
    buffer_load_dwordx4 v[88:91], v2, s[32:35], s49 offen nt
    s_xor_b32 s49, s48, 53248
    buffer_load_dwordx4 v[92:95], v2, s[32:35], s49 offen nt
    s_xor_b32 s49, s48, 57344
    buffer_load_dwordx4 v[96:99], v2, s[32:35], s49 offen nt
    s_xor_b32 s49, s48, 61440
    buffer_load_dwordx4 v[100:103], v2, s[32:35], s49 offen nt
    s_xor_b32 s49, s48, 65536
    buffer_load_dwordx4 v[104:107], v2, s[32:35], s49 offen nt
    s_xor_b32 s49, s48, 69632
    buffer_load_dwordx4 v[108:111], v2, s[32:35], s49 offen nt
    s_xor_b32 s49, s48, 73728
    buffer_load_dwordx4 v[112:115], v2, s[32:35], s49 offen nt
    s_xor_b32 s49, s48, 77824
    buffer_load_dwordx4 v[116:119], v2, s[32:35], s49 offen nt
    s_branch L_STREAM2
L_CODE_END:

    s_endpgm
.fill 260, 4, 0xbf800000
.section .rodata,"a"
.p2align 6
.amdhsa_kernel recurrent_scan__gqa_block_cached__mixer_token_mlp__decode_kernel
  .amdhsa_next_free_vgpr 256
  .amdhsa_next_free_sgpr 102
  .amdhsa_accum_offset 168
  .amdhsa_group_segment_fixed_size 0
  .amdhsa_kernarg_size 104
  .amdhsa_user_sgpr_count 2
  .amdhsa_user_sgpr_kernarg_segment_ptr 1
  .amdhsa_system_sgpr_workgroup_id_x 1
  .amdhsa_float_denorm_mode_32 3
.end_amdhsa_kernel
```
